```python
import torch

def _softmax(x, axis=-1):
    return torch.softmax(x, dim=axis)
def _gelu(x):
    return torch.nn.functional.gelu(x, approximate="tanh")
def _silu(x):
    return torch.nn.functional.silu(x)
def _sigmoid(x):
    return torch.sigmoid(x)
def _layernorm(x, axis=-1, eps=1e-5):
    m = x.mean(dim=axis, keepdim=True)
    v = x.var(dim=axis, keepdim=True, unbiased=False)
    return (x - m) / torch.sqrt(v + eps)
def _scatter_add(tgt, idx, src, axis=0):
    return tgt.clone().index_add_(axis, idx, src)
def _segment_sum(src, seg, n):
    out = torch.zeros((n,) + src.shape[1:], dtype=src.dtype)
    return out.index_add_(0, seg, src)
def _pad(x, pw):
    flat = tuple(v for pair in reversed(pw) for v in pair)
    return torch.nn.functional.pad(x, flat)

kernel_name = 'concat_heads__mha_block_cached__mha_block_cached__near_ridge'

def setup_inputs():

    _w = (lambda a: (lambda t: t.to(torch.bfloat16) if t.is_floating_point() else t)(torch.as_tensor(a)))
    def _A_setup():
        B, Sq, D = 8, 128, 512
        H, Sk, Dh = 32, 512, 128
        return {
            "x": _w((lambda *s: torch.randn(*s, dtype=torch.bfloat16) * 0.8)(B, Sq, D)),
            "k_cache": _w((lambda *s: torch.randn(*s, dtype=torch.bfloat16) * 0.8)(B, H, Sk, Dh)),
            "v_cache": _w((lambda *s: torch.randn(*s, dtype=torch.bfloat16) * 0.05)(B, H, Sk, Dh)),
            "wq": _w((lambda *s: torch.randn(*s, dtype=torch.bfloat16) * 0.8)(D, H * Dh) * (D ** -0.5)),
            "wo": _w((lambda *s: torch.randn(*s, dtype=torch.bfloat16) * 0.05)(H * Dh, D) * ((H * Dh) ** -0.5)),
        }
    _A_in = _A_setup()

    def _B_setup():
        B, Sq, D = 8, 128, 512
        H, Sk, Dh = 32, 512, 128
        return {
            "x": _w((lambda *s: torch.randn(*s, dtype=torch.bfloat16) * 0.8)(B, Sq, D)),
            "k_cache": _w((lambda *s: torch.randn(*s, dtype=torch.bfloat16) * 0.8)(B, H, Sk, Dh)),
            "v_cache": _w((lambda *s: torch.randn(*s, dtype=torch.bfloat16) * 0.05)(B, H, Sk, Dh)),
            "wq": _w((lambda *s: torch.randn(*s, dtype=torch.bfloat16) * 0.8)(D, H * Dh) * (D ** -0.5)),
            "wo": _w((lambda *s: torch.randn(*s, dtype=torch.bfloat16) * 0.05)(H * Dh, D) * ((H * Dh) ** -0.5)),
        }
    _B_in = _B_setup()

    return {
        "A_x": _A_in["x"],
        "A_k_cache": _A_in["k_cache"],
        "A_v_cache": _A_in["v_cache"],
        "A_wq": _A_in["wq"],
        "A_wo": _A_in["wo"],
        "B_x": _B_in["x"],
        "B_k_cache": _B_in["k_cache"],
        "B_v_cache": _B_in["v_cache"],
        "B_wq": _B_in["wq"],
        "B_wo": _B_in["wo"],
    }

def reference(A_x, A_k_cache, A_v_cache, A_wq, A_wo, B_x, B_k_cache, B_v_cache, B_wq, B_wo):
    def _A_ref(x, k_cache, v_cache, wq, wo):
        B, Sq, D = x.shape
        H, Dh = 32, 128
        q = (lambda x, *d: x.permute(*d))((x @ wq).reshape(B, Sq, H, Dh), 0, 2, 1, 3)
        scores = torch.einsum("bhqd,bhkd->bhqk", q, k_cache) * (Dh ** -0.5)
        p = _softmax(scores, axis=-1)
        o = torch.einsum("bhqk,bhkd->bhqd", p, v_cache)
        return (lambda x, *d: x.permute(*d))(o, 0, 2, 1, 3).reshape(B, Sq, H * Dh) @ wo

    def _B_ref(x, k_cache, v_cache, wq, wo):
        B, Sq, D = x.shape
        H, Dh = 32, 128
        q = (lambda x, *d: x.permute(*d))((x @ wq).reshape(B, Sq, H, Dh), 0, 2, 1, 3)
        scores = torch.einsum("bhqd,bhkd->bhqk", q, k_cache) * (Dh ** -0.5)
        p = _softmax(scores, axis=-1)
        o = torch.einsum("bhqk,bhkd->bhqd", p, v_cache)
        return (lambda x, *d: x.permute(*d))(o, 0, 2, 1, 3).reshape(B, Sq, H * Dh) @ wo

    a = _A_ref(A_x, A_k_cache, A_v_cache, A_wq, A_wo)
    b = _B_ref(B_x, B_k_cache, B_v_cache, B_wq, B_wo)
    return torch.concatenate([a, b], axis=-1)
```

```asm
; @launch grid=(256,1,1) block=(512,1,1) lds=163840
.amdgcn_target "amdgcn-amd-amdhsa--gfx950"
.text
.globl concat_heads__mha_block_cached__mha_block_cached__near_ridge_kernel
.p2align 8
.type concat_heads__mha_block_cached__mha_block_cached__near_ridge_kernel,@function
concat_heads__mha_block_cached__mha_block_cached__near_ridge_kernel:
    s_cmp_ge_u32 s2, 256
    s_cbranch_scc1 L_k1_end
    s_load_dwordx16 s[48:63], s[0:1], 0
    s_load_dwordx4 s[64:67], s[0:1], 64
    s_load_dwordx2 s[68:69], s[0:1], 96
    s_load_dwordx4 s[84:87], s[0:1], 80
    v_mov_b32 v255, v0
    v_lshrrev_b32 v1, 6, v0
    s_and_b32 s44, s2, 7
    v_readfirstlane_b32 s24, v1
    s_lshr_b32 s45, s2, 3
    s_lshr_b32 s29, s44, 2
    s_and_b32 s92, s44, 3
    s_lshl_b32 s79, s92, 2
    s_lshr_b32 s93, s45, 3
    s_and_b32 s27, s45, 7
    s_add_u32 s28, s79, s93
    s_and_b32 s25, s24, 3
    s_lshr_b32 s26, s24, 2
    s_lshl_b32 s30, s25, 12
    s_lshl_b32 s44, s29, 3
    s_add_u32 s44, s44, s27
    s_lshl_b32 s95, s44, 4
    s_lshl_b32 s45, s92, 2
    s_add_u32 s94, s95, s45
    s_add_u32 s3, s94, s93
    s_lshl_b32 s3, s3, 8
    s_add_u32 s3, s3, 0x3000000
    s_lshl_b32 s44, s44, 2
    s_add_u32 s44, s44, s25
    s_lshl_b32 s97, s44, 18
    s_waitcnt lgkmcnt(0)
    s_mov_b32 s88, s84
    s_mov_b32 s89, s85
    s_mov_b32 s90, 0x200000
    s_mov_b32 s91, 0x20000
    s_mov_b32 s84, s86
    s_mov_b32 s85, s87
    s_mov_b32 s86, 256
    s_mov_b32 s87, 0x20000
    s_cmp_eq_u32 s29, 0
    s_cselect_b32 s16, s48, s58
    s_cselect_b32 s17, s49, s59
    s_mov_b32 s18, 0x100000
    s_mov_b32 s19, 0x20000
    s_cselect_b32 s4, s50, s60
    s_cselect_b32 s5, s51, s61
    s_mov_b32 s6, 0x2000000
    s_mov_b32 s7, 0x20000
    s_cselect_b32 s8, s52, s62
    s_cselect_b32 s9, s53, s63
    s_mov_b32 s10, 0x2000000
    s_mov_b32 s11, 0x20000
    s_cselect_b32 s12, s54, s64
    s_cselect_b32 s13, s55, s65
    s_mov_b32 s14, 0x400000
    s_mov_b32 s15, 0x20000
    s_cselect_b32 s80, s56, s66
    s_cselect_b32 s81, s57, s67
    s_mov_b32 s82, 0x400000
    s_mov_b32 s83, 0x20000
    s_mov_b32 s20, s68
    s_mov_b32 s21, s69
    s_mov_b32 s22, 0x10000000
    s_mov_b32 s23, 0x20000
    s_xor_b32 s48, s93, 2
    s_xor_b32 s49, s93, 1
    s_sub_u32 s50, s48, s93
    s_add_u32 s50, s50, 15
    s_lshl_b32 s50, s50, 17
    s_cmp_eq_u32 s26, 0
    s_cbranch_scc0 L_y_start
    v_and_b32 v238, 1, v255
    v_lshlrev_b32 v238, 21, v238
    s_mov_b64 exec, 3
    s_cmp_eq_u32 s25, 0
    s_cbranch_scc0 L_wm0
    s_lshl_b32 s44, s27, 5
    s_add_u32 s44, s44, s28
    s_lshl_b32 s44, s44, 17
    buffer_load_dword v244, v238, s[4:7], s44 offen
L_wm0:
    s_cmp_eq_u32 s25, 1
    s_cbranch_scc0 L_wm1
    s_lshl_b32 s44, s27, 5
    s_add_u32 s44, s44, s28
    s_lshl_b32 s44, s44, 17
    buffer_load_dword v244, v238, s[8:11], s44 offen
L_wm1:
    s_cmp_eq_u32 s25, 2
    s_cbranch_scc0 L_wm2
    s_lshl_b32 s44, s79, 17
    buffer_load_dword v244, v238, s[80:83], s44 offen
L_wm2:
    s_cmp_eq_u32 s25, 3
    s_cbranch_scc0 L_wm3
L_wm3:
    s_mov_b64 exec, -1
    s_cmp_eq_u32 s25, 0
    s_cbranch_scc0 L_ni
    v_and_b32 v238, 63, v255
    v_lshlrev_b32 v238, 2, v238
    v_mov_b32 v239, 0
    buffer_store_dword v239, v238, s[20:23], s3 offen sc1
L_ni:
    v_mov_b32 v96, 0
    v_mov_b32 v97, 0
    v_mov_b32 v98, 0
    v_mov_b32 v99, 0
    v_mov_b32 v100, 0
    v_mov_b32 v101, 0
    v_mov_b32 v102, 0
    v_mov_b32 v103, 0
    v_mov_b32 v246, 0
    v_mov_b32 v247, 0
    v_mov_b32 v248, 0
    v_mov_b32 v249, 0
    v_mov_b32 v250, 0
    s_mov_b32 s36, 0
    v_and_b32 v238, 63, v255
    v_lshrrev_b32 v239, 4, v238
    v_lshrrev_b32 v240, 5, v238
    v_bfe_u32 v241, v238, 2, 2
    v_and_b32 v242, 3, v238
    v_lshl_add_u32 v243, v240, 2, v241
    v_lshlrev_b32 v243, 8, v243
    s_add_u32 s44, s36, 0x4000
    v_add_u32 v243, s44, v243
    v_and_b32 v236, 1, v239
    v_lshl_add_u32 v243, v236, 5, v243
    v_lshrrev_b32 v236, 1, v242
    v_lshl_add_u32 v243, v236, 4, v243
    v_and_b32 v236, 1, v242
    v_lshl_add_u32 v243, v236, 3, v243
    v_xor_b32 v236, 0, v241
    v_lshl_add_u32 v232, v236, 6, v243
    v_xor_b32 v236, 1, v241
    v_lshl_add_u32 v233, v236, 6, v243
    v_xor_b32 v236, 2, v241
    v_lshl_add_u32 v234, v236, 6, v243
    v_xor_b32 v236, 3, v241
    v_lshl_add_u32 v235, v236, 6, v243
    v_and_b32 v243, 31, v238
    v_and_b32 v241, 15, v238
    v_lshlrev_b32 v243, 8, v243
    v_add_u32 v243, s36, v243
    v_add_u32 v236, 0, v240
    v_xor_b32 v236, v236, v241
    v_lshl_add_u32 v224, v236, 4, v243
    v_add_u32 v236, 2, v240
    v_xor_b32 v236, v236, v241
    v_lshl_add_u32 v225, v236, 4, v243
    v_add_u32 v236, 4, v240
    v_xor_b32 v236, v236, v241
    v_lshl_add_u32 v226, v236, 4, v243
    v_add_u32 v236, 6, v240
    v_xor_b32 v236, v236, v241
    v_lshl_add_u32 v227, v236, 4, v243
    v_add_u32 v236, 8, v240
    v_xor_b32 v236, v236, v241
    v_lshl_add_u32 v228, v236, 4, v243
    v_add_u32 v236, 10, v240
    v_xor_b32 v236, v236, v241
    v_lshl_add_u32 v229, v236, 4, v243
    v_add_u32 v236, 12, v240
    v_xor_b32 v236, v236, v241
    v_lshl_add_u32 v230, v236, 4, v243
    v_add_u32 v236, 14, v240
    v_xor_b32 v236, v236, v241
    v_lshl_add_u32 v231, v236, 4, v243
    v_mov_b32 v237, 0
    v_mov_b32 v128, 0
    v_mov_b32 v129, 0
    v_mov_b32 v130, 0
    v_mov_b32 v131, 0
    v_mov_b32 v132, 0
    v_mov_b32 v133, 0
    v_mov_b32 v134, 0
    v_mov_b32 v135, 0
    v_mov_b32 v136, 0
    v_mov_b32 v137, 0
    v_mov_b32 v138, 0
    v_mov_b32 v139, 0
    v_mov_b32 v140, 0
    v_mov_b32 v141, 0
    v_mov_b32 v142, 0
    v_mov_b32 v143, 0
    s_mov_b32 s36, 65536
    s_mov_b32 s32, 0x33243243
    s_mov_b32 s34, 0
    s_mov_b32 s77, 0
    v_and_b32 v238, 63, v255
    v_lshrrev_b32 v239, 4, v238
    v_lshrrev_b32 v240, 5, v238
    v_bfe_u32 v241, v238, 2, 2
    v_and_b32 v242, 3, v238
    v_lshl_add_u32 v243, v240, 3, v241
    v_lshlrev_b32 v243, 8, v243
    v_add_u32 v243, s36, v243
    v_and_b32 v108, 1, v239
    v_lshlrev_b32 v108, 5, v108
    v_add_u32 v243, v243, v108
    v_and_b32 v108, 1, v242
    v_lshl_add_u32 v243, v108, 4, v243
    v_lshrrev_b32 v108, 1, v242
    v_lshl_add_u32 v243, v108, 3, v243
    v_xor_b32 v108, 0, v241
    v_lshl_add_u32 v104, v108, 6, v243
    v_xor_b32 v108, 1, v241
    v_lshl_add_u32 v105, v108, 6, v243
    v_xor_b32 v108, 2, v241
    v_lshl_add_u32 v106, v108, 6, v243
    v_xor_b32 v108, 3, v241
    v_lshl_add_u32 v107, v108, 6, v243
    v_and_b32 v243, 31, v238
    v_bfe_u32 v241, v243, 1, 3
    s_lshl_b32 s44, s25, 12
    s_add_u32 s44, s44, s36
    s_add_u32 s44, s44, 0x4000
    v_lshlrev_b32 v243, 7, v243
    v_add_u32 v243, s44, v243
    v_add_u32 v242, 0, v240
    v_xor_b32 v242, v242, v241
    v_lshl_add_u32 v108, v242, 4, v243
    v_add_u32 v242, 2, v240
    v_xor_b32 v242, v242, v241
    v_lshl_add_u32 v109, v242, 4, v243
    v_add_u32 v242, 4, v240
    v_xor_b32 v242, v242, v241
    v_lshl_add_u32 v110, v242, 4, v243
    v_add_u32 v242, 6, v240
    v_xor_b32 v242, v242, v241
    v_lshl_add_u32 v111, v242, 4, v243
    v_mov_b32 v0, 0
    v_mov_b32 v1, 0
    v_mov_b32 v2, 0
    v_mov_b32 v3, 0
    v_mov_b32 v4, 0
    v_mov_b32 v5, 0
    v_mov_b32 v6, 0
    v_mov_b32 v7, 0
    v_mov_b32 v8, 0
    v_mov_b32 v9, 0
    v_mov_b32 v10, 0
    v_mov_b32 v11, 0
    v_mov_b32 v12, 0
    v_mov_b32 v13, 0
    v_mov_b32 v14, 0
    v_mov_b32 v15, 0
    v_mov_b32 v16, 0
    v_mov_b32 v17, 0
    v_mov_b32 v18, 0
    v_mov_b32 v19, 0
    v_mov_b32 v20, 0
    v_mov_b32 v21, 0
    v_mov_b32 v22, 0
    v_mov_b32 v23, 0
    v_mov_b32 v24, 0
    v_mov_b32 v25, 0
    v_mov_b32 v26, 0
    v_mov_b32 v27, 0
    v_mov_b32 v28, 0
    v_mov_b32 v29, 0
    v_mov_b32 v30, 0
    v_mov_b32 v31, 0
    v_mov_b32 v32, 0
    v_mov_b32 v33, 0
    v_mov_b32 v34, 0
    v_mov_b32 v35, 0
    v_mov_b32 v36, 0
    v_mov_b32 v37, 0
    v_mov_b32 v38, 0
    v_mov_b32 v39, 0
    v_mov_b32 v40, 0
    v_mov_b32 v41, 0
    v_mov_b32 v42, 0
    v_mov_b32 v43, 0
    v_mov_b32 v44, 0
    v_mov_b32 v45, 0
    v_mov_b32 v46, 0
    v_mov_b32 v47, 0
    v_mov_b32 v48, 0
    v_mov_b32 v49, 0
    v_mov_b32 v50, 0
    v_mov_b32 v51, 0
    v_mov_b32 v52, 0
    v_mov_b32 v53, 0
    v_mov_b32 v54, 0
    v_mov_b32 v55, 0
    v_mov_b32 v56, 0
    v_mov_b32 v57, 0
    v_mov_b32 v58, 0
    v_mov_b32 v59, 0
    v_mov_b32 v60, 0
    v_mov_b32 v61, 0
    v_mov_b32 v62, 0
    v_mov_b32 v63, 0
    s_mov_b32 s64, 0
    s_mov_b32 s65, 0
    s_mov_b32 s66, 0
    s_mov_b32 s38, 0
    s_mov_b32 s39, 0
    s_mov_b32 s43, 0
    s_mov_b32 s33, 0
    s_mov_b32 s78, 0
    s_barrier
    s_branch L_qp_start
L_y_start:
    v_and_b32 v238, 63, v255
    v_lshrrev_b32 v239, 4, v238
    v_and_b32 v241, 15, v238
    v_lshlrev_b32 v243, 2, v239
    v_xor_b32 v243, v243, v241
    v_lshlrev_b32 v243, 4, v243
    v_lshl_add_u32 v243, v239, 13, v243
    s_lshl_b32 s44, s25, 17
    v_add_u32 v96, s44, v243
    v_add_u32 v97, 31744, v96
    v_add_u32 v98, 63488, v96
    v_add_u32 v99, 95232, v96
    v_lshrrev_b32 v240, 3, v238
    v_lshlrev_b32 v240, 10, v240
    s_lshl_b32 s44, s25, 15
    v_add_u32 v240, s44, v240
    v_and_b32 v241, 7, v238
    v_add_u32 v243, 0, v239
    v_and_b32 v243, 7, v243
    v_xor_b32 v243, v243, v241
    v_lshl_add_u32 v100, v243, 4, v240
    v_add_u32 v243, 4, v239
    v_and_b32 v243, 7, v243
    v_xor_b32 v243, v243, v241
    v_lshl_add_u32 v101, v243, 4, v240
    v_add_u32 v101, 7168, v101
    v_add_u32 v243, 8, v239
    v_and_b32 v243, 7, v243
    v_xor_b32 v243, v243, v241
    v_lshl_add_u32 v102, v243, 4, v240
    v_add_u32 v102, 14336, v102
    v_add_u32 v243, 12, v239
    v_and_b32 v243, 7, v243
    v_xor_b32 v243, v243, v241
    v_lshl_add_u32 v103, v243, 4, v240
    v_add_u32 v103, 21504, v103
    s_lshl_b32 s65, s28, 8
    s_lshl_b32 s66, s27, 17
    s_lshl_b32 s64, s93, 1
    s_add_u32 s64, s64, s27
    s_sub_u32 s64, s64, 1
    s_add_u32 s64, s64, 1
    s_and_b32 s64, s64, 7
    s_lshl_b32 s38, s64, 19
    s_add_u32 s38, s38, s65
    s_lshl_b32 s39, s64, 7
    s_add_u32 s39, s39, s66
    s_mov_b32 s45, 65536
    s_add_u32 m0, s45, s30
    s_nop 0
    buffer_load_dwordx4 v96, s[12:15], s38 offen offset:0  lds
    buffer_load_dwordx4 v97, s[12:15], s38 offen offset:1024  lds
    buffer_load_dwordx4 v98, s[12:15], s38 offen offset:2048  lds
    buffer_load_dwordx4 v99, s[12:15], s38 offen offset:3072  lds
    s_add_u32 m0, s45, s30
    s_add_u32 m0, m0, 0x4000
    s_nop 0
    buffer_load_dwordx4 v100, s[16:19], s39 offen offset:0  lds
    buffer_load_dwordx4 v101, s[16:19], s39 offen offset:1024  lds
    buffer_load_dwordx4 v102, s[16:19], s39 offen offset:2048  lds
    buffer_load_dwordx4 v103, s[16:19], s39 offen offset:3072  lds
    s_add_u32 s64, s64, 1
    s_and_b32 s64, s64, 7
    s_lshl_b32 s38, s64, 19
    s_add_u32 s38, s38, s65
    s_lshl_b32 s39, s64, 7
    s_add_u32 s39, s39, s66
    s_mov_b32 s45, 98304
    s_add_u32 m0, s45, s30
    s_nop 0
    buffer_load_dwordx4 v96, s[12:15], s38 offen offset:0  lds
    buffer_load_dwordx4 v97, s[12:15], s38 offen offset:1024  lds
    buffer_load_dwordx4 v98, s[12:15], s38 offen offset:2048  lds
    buffer_load_dwordx4 v99, s[12:15], s38 offen offset:3072  lds
    s_add_u32 m0, s45, s30
    s_add_u32 m0, m0, 0x4000
    s_nop 0
    buffer_load_dwordx4 v100, s[16:19], s39 offen offset:0  lds
    buffer_load_dwordx4 v101, s[16:19], s39 offen offset:1024  lds
    buffer_load_dwordx4 v102, s[16:19], s39 offen offset:2048  lds
    buffer_load_dwordx4 v103, s[16:19], s39 offen offset:3072  lds
    s_add_u32 s64, s64, 1
    s_and_b32 s64, s64, 7
    s_lshl_b32 s38, s64, 19
    s_add_u32 s38, s38, s65
    s_lshl_b32 s39, s64, 7
    s_add_u32 s39, s39, s66
    s_mov_b32 s45, 131072
    s_add_u32 m0, s45, s30
    s_nop 0
    buffer_load_dwordx4 v96, s[12:15], s38 offen offset:0  lds
    buffer_load_dwordx4 v97, s[12:15], s38 offen offset:1024  lds
    buffer_load_dwordx4 v98, s[12:15], s38 offen offset:2048  lds
    buffer_load_dwordx4 v99, s[12:15], s38 offen offset:3072  lds
    s_add_u32 m0, s45, s30
    s_add_u32 m0, m0, 0x4000
    s_nop 0
    buffer_load_dwordx4 v100, s[16:19], s39 offen offset:0  lds
    buffer_load_dwordx4 v101, s[16:19], s39 offen offset:1024  lds
    buffer_load_dwordx4 v102, s[16:19], s39 offen offset:2048  lds
    buffer_load_dwordx4 v103, s[16:19], s39 offen offset:3072  lds
    s_add_u32 s64, s64, 1
    s_and_b32 s64, s64, 7
    s_lshl_b32 s38, s64, 19
    s_add_u32 s38, s38, s65
    s_lshl_b32 s39, s64, 7
    s_add_u32 s39, s39, s66
    s_waitcnt vmcnt(16)
    s_barrier
    v_and_b32 v238, 63, v255
    v_lshrrev_b32 v239, 4, v238
    s_lshl_b32 s44, s25, 12
    v_lshlrev_b32 v240, 8, v239
    v_add_u32 v240, s44, v240
    v_and_b32 v241, 15, v238
    v_add_u32 v243, 0, v239
    v_xor_b32 v243, v243, v241
    v_lshl_add_u32 v246, v243, 4, v240
    v_add_u32 v243, 4, v239
    v_xor_b32 v243, v243, v241
    v_lshl_add_u32 v247, v243, 4, v240
    v_add_u32 v243, 8, v239
    v_xor_b32 v243, v243, v241
    v_lshl_add_u32 v248, v243, 4, v240
    v_add_u32 v243, 12, v239
    v_xor_b32 v243, v243, v241
    v_lshl_add_u32 v249, v243, 4, v240
    v_lshlrev_b32 v243, 2, v239
    v_xor_b32 v243, v243, v241
    v_lshl_add_u32 v250, v243, 4, v240
    s_lshl_b32 s44, s27, 5
    s_add_u32 s44, s44, s79
    s_add_u32 s44, s44, s93
    s_lshl_b32 s43, s44, 17
    s_mov_b32 s36, 65536
    v_and_b32 v238, 63, v255
    v_lshrrev_b32 v239, 4, v238
    v_lshrrev_b32 v240, 5, v238
    v_bfe_u32 v241, v238, 2, 2
    v_and_b32 v242, 3, v238
    v_lshl_add_u32 v243, v240, 2, v241
    v_lshlrev_b32 v243, 8, v243
    s_add_u32 s44, s36, 0x4000
    v_add_u32 v243, s44, v243
    v_and_b32 v236, 1, v239
    v_lshl_add_u32 v243, v236, 5, v243
    v_lshrrev_b32 v236, 1, v242
    v_lshl_add_u32 v243, v236, 4, v243
    v_and_b32 v236, 1, v242
    v_lshl_add_u32 v243, v236, 3, v243
    v_xor_b32 v236, 0, v241
    v_lshl_add_u32 v232, v236, 6, v243
    v_xor_b32 v236, 1, v241
    v_lshl_add_u32 v233, v236, 6, v243
    v_xor_b32 v236, 2, v241
    v_lshl_add_u32 v234, v236, 6, v243
    v_xor_b32 v236, 3, v241
    v_lshl_add_u32 v235, v236, 6, v243
    v_and_b32 v243, 31, v238
    v_and_b32 v241, 15, v238
    v_lshlrev_b32 v243, 8, v243
    v_add_u32 v243, s36, v243
    v_add_u32 v236, 0, v240
    v_xor_b32 v236, v236, v241
    v_lshl_add_u32 v224, v236, 4, v243
    v_add_u32 v236, 2, v240
    v_xor_b32 v236, v236, v241
    v_lshl_add_u32 v225, v236, 4, v243
    v_add_u32 v236, 4, v240
    v_xor_b32 v236, v236, v241
    v_lshl_add_u32 v226, v236, 4, v243
    v_add_u32 v236, 6, v240
    v_xor_b32 v236, v236, v241
    v_lshl_add_u32 v227, v236, 4, v243
    v_add_u32 v236, 8, v240
    v_xor_b32 v236, v236, v241
    v_lshl_add_u32 v228, v236, 4, v243
    v_add_u32 v236, 10, v240
    v_xor_b32 v236, v236, v241
    v_lshl_add_u32 v229, v236, 4, v243
    v_add_u32 v236, 12, v240
    v_xor_b32 v236, v236, v241
    v_lshl_add_u32 v230, v236, 4, v243
    v_add_u32 v236, 14, v240
    v_xor_b32 v236, v236, v241
    v_lshl_add_u32 v231, v236, 4, v243
    v_mov_b32 v237, 0
    v_mov_b32 v128, 0
    v_mov_b32 v129, 0
    v_mov_b32 v130, 0
    v_mov_b32 v131, 0
    v_mov_b32 v132, 0
    v_mov_b32 v133, 0
    v_mov_b32 v134, 0
    v_mov_b32 v135, 0
    v_mov_b32 v136, 0
    v_mov_b32 v137, 0
    v_mov_b32 v138, 0
    v_mov_b32 v139, 0
    v_mov_b32 v140, 0
    v_mov_b32 v141, 0
    v_mov_b32 v142, 0
    v_mov_b32 v143, 0
    s_mov_b32 s36, 131072
    s_mov_b32 s32, 0x33434343
    s_mov_b32 s33, 0x3434343
    s_mov_b32 s78, 0x2102102
    s_mov_b32 s34, 0x7f
    s_mov_b32 s77, 0xff
    v_and_b32 v238, 63, v255
    v_lshrrev_b32 v239, 4, v238
    v_lshrrev_b32 v240, 5, v238
    v_bfe_u32 v241, v238, 2, 2
    v_and_b32 v242, 3, v238
    v_lshl_add_u32 v243, v240, 3, v241
    v_lshlrev_b32 v243, 8, v243
    v_add_u32 v243, s36, v243
    v_and_b32 v108, 1, v239
    v_lshlrev_b32 v108, 5, v108
    v_add_u32 v243, v243, v108
    v_and_b32 v108, 1, v242
    v_lshl_add_u32 v243, v108, 4, v243
    v_lshrrev_b32 v108, 1, v242
    v_lshl_add_u32 v243, v108, 3, v243
    v_xor_b32 v108, 0, v241
    v_lshl_add_u32 v104, v108, 6, v243
    v_xor_b32 v108, 1, v241
    v_lshl_add_u32 v105, v108, 6, v243
    v_xor_b32 v108, 2, v241
    v_lshl_add_u32 v106, v108, 6, v243
    v_xor_b32 v108, 3, v241
    v_lshl_add_u32 v107, v108, 6, v243
    v_and_b32 v243, 31, v238
    v_bfe_u32 v241, v243, 1, 3
    s_lshl_b32 s44, s25, 12
    s_add_u32 s44, s44, s36
    s_add_u32 s44, s44, 0x4000
    v_lshlrev_b32 v243, 7, v243
    v_add_u32 v243, s44, v243
    v_add_u32 v242, 0, v240
    v_xor_b32 v242, v242, v241
    v_lshl_add_u32 v108, v242, 4, v243
    v_add_u32 v242, 2, v240
    v_xor_b32 v242, v242, v241
    v_lshl_add_u32 v109, v242, 4, v243
    v_add_u32 v242, 4, v240
    v_xor_b32 v242, v242, v241
    v_lshl_add_u32 v110, v242, 4, v243
    v_add_u32 v242, 6, v240
    v_xor_b32 v242, v242, v241
    v_lshl_add_u32 v111, v242, 4, v243
    v_mov_b32 v0, 0
    v_mov_b32 v1, 0
    v_mov_b32 v2, 0
    v_mov_b32 v3, 0
    v_mov_b32 v4, 0
    v_mov_b32 v5, 0
    v_mov_b32 v6, 0
    v_mov_b32 v7, 0
    v_mov_b32 v8, 0
    v_mov_b32 v9, 0
    v_mov_b32 v10, 0
    v_mov_b32 v11, 0
    v_mov_b32 v12, 0
    v_mov_b32 v13, 0
    v_mov_b32 v14, 0
    v_mov_b32 v15, 0
    v_mov_b32 v16, 0
    v_mov_b32 v17, 0
    v_mov_b32 v18, 0
    v_mov_b32 v19, 0
    v_mov_b32 v20, 0
    v_mov_b32 v21, 0
    v_mov_b32 v22, 0
    v_mov_b32 v23, 0
    v_mov_b32 v24, 0
    v_mov_b32 v25, 0
    v_mov_b32 v26, 0
    v_mov_b32 v27, 0
    v_mov_b32 v28, 0
    v_mov_b32 v29, 0
    v_mov_b32 v30, 0
    v_mov_b32 v31, 0
    v_mov_b32 v32, 0
    v_mov_b32 v33, 0
    v_mov_b32 v34, 0
    v_mov_b32 v35, 0
    v_mov_b32 v36, 0
    v_mov_b32 v37, 0
    v_mov_b32 v38, 0
    v_mov_b32 v39, 0
    v_mov_b32 v40, 0
    v_mov_b32 v41, 0
    v_mov_b32 v42, 0
    v_mov_b32 v43, 0
    v_mov_b32 v44, 0
    v_mov_b32 v45, 0
    v_mov_b32 v46, 0
    v_mov_b32 v47, 0
    v_mov_b32 v48, 0
    v_mov_b32 v49, 0
    v_mov_b32 v50, 0
    v_mov_b32 v51, 0
    v_mov_b32 v52, 0
    v_mov_b32 v53, 0
    v_mov_b32 v54, 0
    v_mov_b32 v55, 0
    v_mov_b32 v56, 0
    v_mov_b32 v57, 0
    v_mov_b32 v58, 0
    v_mov_b32 v59, 0
    v_mov_b32 v60, 0
    v_mov_b32 v61, 0
    v_mov_b32 v62, 0
    v_mov_b32 v63, 0
    s_waitcnt vmcnt(8)
    s_barrier
    s_mov_b32 s45, 65536
    s_add_u32 m0, s45, s30
    s_nop 0
    buffer_load_dwordx4 v96, s[12:15], s38 offen offset:0  lds
    buffer_load_dwordx4 v97, s[12:15], s38 offen offset:1024  lds
    buffer_load_dwordx4 v98, s[12:15], s38 offen offset:2048  lds
    buffer_load_dwordx4 v99, s[12:15], s38 offen offset:3072  lds
    s_add_u32 m0, s45, s30
    s_add_u32 m0, m0, 0x4000
    s_nop 0
    buffer_load_dwordx4 v100, s[16:19], s39 offen offset:0  lds
    buffer_load_dwordx4 v101, s[16:19], s39 offen offset:1024  lds
    buffer_load_dwordx4 v102, s[16:19], s39 offen offset:2048  lds
    buffer_load_dwordx4 v103, s[16:19], s39 offen offset:3072  lds
    s_add_u32 s64, s64, 1
    s_and_b32 s64, s64, 7
    s_lshl_b32 s38, s64, 19
    s_add_u32 s38, s38, s65
    s_lshl_b32 s39, s64, 7
    s_add_u32 s39, s39, s66
    s_mov_b32 s45, 0
    s_add_u32 m0, s45, s30
    s_nop 0
    buffer_load_dwordx4 v246, s[4:7], s43 offen offset:0 nt lds
    buffer_load_dwordx4 v247, s[4:7], s43 offen offset:1024 nt lds
    buffer_load_dwordx4 v248, s[4:7], s43 offen offset:2048 nt lds
    buffer_load_dwordx4 v249, s[4:7], s43 offen offset:3072 nt lds
    s_waitcnt vmcnt(12)
    s_barrier
    s_mov_b32 s45, 98304
    s_add_u32 m0, s45, s30
    s_nop 0
    buffer_load_dwordx4 v96, s[12:15], s38 offen offset:0  lds
    buffer_load_dwordx4 v97, s[12:15], s38 offen offset:1024  lds
    buffer_load_dwordx4 v98, s[12:15], s38 offen offset:2048  lds
    buffer_load_dwordx4 v99, s[12:15], s38 offen offset:3072  lds
    s_add_u32 m0, s45, s30
    s_add_u32 m0, m0, 0x4000
    s_nop 0
    buffer_load_dwordx4 v100, s[16:19], s39 offen offset:0  lds
    buffer_load_dwordx4 v101, s[16:19], s39 offen offset:1024  lds
    buffer_load_dwordx4 v102, s[16:19], s39 offen offset:2048  lds
    buffer_load_dwordx4 v103, s[16:19], s39 offen offset:3072  lds
    s_add_u32 s64, s64, 1
    s_and_b32 s64, s64, 7
    s_lshl_b32 s38, s64, 19
    s_add_u32 s38, s38, s65
    s_lshl_b32 s39, s64, 7
    s_add_u32 s39, s39, s66
    s_waitcnt vmcnt(12)
    s_barrier
    s_mov_b32 s45, 131072
    s_add_u32 m0, s45, s30
    s_nop 0
    buffer_load_dwordx4 v96, s[12:15], s38 offen offset:0  lds
    buffer_load_dwordx4 v97, s[12:15], s38 offen offset:1024  lds
    buffer_load_dwordx4 v98, s[12:15], s38 offen offset:2048  lds
    buffer_load_dwordx4 v99, s[12:15], s38 offen offset:3072  lds
    s_add_u32 m0, s45, s30
    s_add_u32 m0, m0, 0x4000
    s_nop 0
    buffer_load_dwordx4 v100, s[16:19], s39 offen offset:0  lds
    buffer_load_dwordx4 v101, s[16:19], s39 offen offset:1024  lds
    buffer_load_dwordx4 v102, s[16:19], s39 offen offset:2048  lds
    buffer_load_dwordx4 v103, s[16:19], s39 offen offset:3072  lds
    s_add_u32 s64, s64, 1
    s_and_b32 s64, s64, 7
    s_lshl_b32 s38, s64, 19
    s_add_u32 s38, s38, s65
    s_lshl_b32 s39, s64, 7
    s_add_u32 s39, s39, s66
    s_mov_b32 s45, 0
    s_add_u32 m0, s45, s30
    s_add_u32 m0, m0, 0x4000
    s_nop 0
    buffer_load_dwordx4 v250, s[8:11], s43 offen offset:0 nt lds
    buffer_load_dwordx4 v250, s[8:11], s43 offen offset:1024 nt lds
    buffer_load_dwordx4 v250, s[8:11], s43 offen offset:2048 nt lds
    buffer_load_dwordx4 v250, s[8:11], s43 offen offset:3072 nt lds
    s_add_u32 s43, s43, 0x4000
    s_waitcnt vmcnt(12)
    s_barrier
    s_mov_b32 s45, 65536
    s_add_u32 m0, s45, s30
    s_nop 0
    buffer_load_dwordx4 v96, s[12:15], s38 offen offset:0  lds
    buffer_load_dwordx4 v97, s[12:15], s38 offen offset:1024  lds
    buffer_load_dwordx4 v98, s[12:15], s38 offen offset:2048  lds
    buffer_load_dwordx4 v99, s[12:15], s38 offen offset:3072  lds
    s_add_u32 m0, s45, s30
    s_add_u32 m0, m0, 0x4000
    s_nop 0
    buffer_load_dwordx4 v100, s[16:19], s39 offen offset:0  lds
    buffer_load_dwordx4 v101, s[16:19], s39 offen offset:1024  lds
    buffer_load_dwordx4 v102, s[16:19], s39 offen offset:2048  lds
    buffer_load_dwordx4 v103, s[16:19], s39 offen offset:3072  lds
    s_add_u32 s64, s64, 1
    s_and_b32 s64, s64, 7
    s_lshl_b32 s38, s64, 19
    s_add_u32 s38, s38, s65
    s_lshl_b32 s39, s64, 7
    s_add_u32 s39, s39, s66
    s_waitcnt vmcnt(12)
    s_barrier
    s_mov_b32 s45, 98304
    s_add_u32 m0, s45, s30
    s_nop 0
    buffer_load_dwordx4 v96, s[12:15], s38 offen offset:0  lds
    buffer_load_dwordx4 v97, s[12:15], s38 offen offset:1024  lds
    buffer_load_dwordx4 v98, s[12:15], s38 offen offset:2048  lds
    buffer_load_dwordx4 v99, s[12:15], s38 offen offset:3072  lds
    s_add_u32 m0, s45, s30
    s_add_u32 m0, m0, 0x4000
    s_nop 0
    buffer_load_dwordx4 v100, s[16:19], s39 offen offset:0  lds
    buffer_load_dwordx4 v101, s[16:19], s39 offen offset:1024  lds
    buffer_load_dwordx4 v102, s[16:19], s39 offen offset:2048  lds
    buffer_load_dwordx4 v103, s[16:19], s39 offen offset:3072  lds
    s_add_u32 s64, s64, 1
    s_and_b32 s64, s64, 7
    s_lshl_b32 s38, s64, 19
    s_add_u32 s38, s38, s65
    s_lshl_b32 s39, s64, 7
    s_add_u32 s39, s39, s66
    s_waitcnt vmcnt(8)
    s_barrier
    s_add_u32 s28, s79, s48
    s_add_u32 s28, s28, 16
    s_lshl_b32 s65, s28, 8
    s_lshl_b32 s66, s27, 17
    s_lshl_b32 s64, s93, 1
    s_add_u32 s64, s64, s27
    s_sub_u32 s64, s64, 1
    s_add_u32 s64, s64, 1
    s_and_b32 s64, s64, 7
    s_lshl_b32 s38, s64, 19
    s_add_u32 s38, s38, s65
    s_lshl_b32 s39, s64, 7
    s_add_u32 s39, s39, s66
    s_mov_b32 s45, 131072
    s_add_u32 m0, s45, s30
    s_nop 0
    buffer_load_dwordx4 v96, s[12:15], s38 offen offset:0  lds
    buffer_load_dwordx4 v97, s[12:15], s38 offen offset:1024  lds
    buffer_load_dwordx4 v98, s[12:15], s38 offen offset:2048  lds
    buffer_load_dwordx4 v99, s[12:15], s38 offen offset:3072  lds
    s_add_u32 m0, s45, s30
    s_add_u32 m0, m0, 0x4000
    s_nop 0
    buffer_load_dwordx4 v100, s[16:19], s39 offen offset:0  lds
    buffer_load_dwordx4 v101, s[16:19], s39 offen offset:1024  lds
    buffer_load_dwordx4 v102, s[16:19], s39 offen offset:2048  lds
    buffer_load_dwordx4 v103, s[16:19], s39 offen offset:3072  lds
    s_add_u32 s64, s64, 1
    s_and_b32 s64, s64, 7
    s_lshl_b32 s38, s64, 19
    s_add_u32 s38, s38, s65
    s_lshl_b32 s39, s64, 7
    s_add_u32 s39, s39, s66
    s_mov_b32 s45, 32768
    s_add_u32 m0, s45, s30
    s_nop 0
    buffer_load_dwordx4 v246, s[4:7], s43 offen offset:0 nt lds
    buffer_load_dwordx4 v247, s[4:7], s43 offen offset:1024 nt lds
    buffer_load_dwordx4 v248, s[4:7], s43 offen offset:2048 nt lds
    buffer_load_dwordx4 v249, s[4:7], s43 offen offset:3072 nt lds
    s_waitcnt vmcnt(12)
    s_barrier
    s_mov_b32 s45, 32768
    s_add_u32 m0, s45, s30
    s_add_u32 m0, m0, 0x4000
    s_nop 0
    buffer_load_dwordx4 v250, s[8:11], s43 offen offset:0 nt lds
    buffer_load_dwordx4 v250, s[8:11], s43 offen offset:1024 nt lds
    buffer_load_dwordx4 v250, s[8:11], s43 offen offset:2048 nt lds
    buffer_load_dwordx4 v250, s[8:11], s43 offen offset:3072 nt lds
    s_add_u32 s43, s43, 0x4000
    s_waitcnt vmcnt(8)
    s_waitcnt lgkmcnt(0)
    s_barrier
L_qp_start:
    s_mov_b32 s31, 0
    ds_read_b128 v[208:211], v108
    ds_read_b64_tr_b16 v[144:145], v104 offset:0
    ds_read_b64_tr_b16 v[146:147], v104 offset:1024
    ds_read_b64_tr_b16 v[148:149], v105 offset:0
    ds_read_b64_tr_b16 v[150:151], v105 offset:1024
    ds_read_b64_tr_b16 v[152:153], v106 offset:0
    ds_read_b64_tr_b16 v[154:155], v106 offset:1024
    ds_read_b64_tr_b16 v[156:157], v107 offset:0
    ds_read_b64_tr_b16 v[158:159], v107 offset:1024
    s_and_b32 s45, s33, 7
    s_lshl_b32 s45, s45, 15
    s_lshr_b32 s33, s33, 4
    s_bitcmp1_b32 s34, s31
    s_cbranch_scc0 L_qpd0_e
    s_add_u32 m0, s45, s30
    s_nop 0
    buffer_load_dwordx4 v96, s[12:15], s38 offen offset:0  lds
    buffer_load_dwordx4 v97, s[12:15], s38 offen offset:1024  lds
    buffer_load_dwordx4 v98, s[12:15], s38 offen offset:2048  lds
    buffer_load_dwordx4 v99, s[12:15], s38 offen offset:3072  lds
L_qpd0_e:
    ds_read_b128 v[212:215], v109
    ds_read_b64_tr_b16 v[160:161], v104 offset:4096
    ds_read_b64_tr_b16 v[162:163], v104 offset:5120
    ds_read_b64_tr_b16 v[164:165], v105 offset:4096
    ds_read_b64_tr_b16 v[166:167], v105 offset:5120
    ds_read_b64_tr_b16 v[168:169], v106 offset:4096
    ds_read_b64_tr_b16 v[170:171], v106 offset:5120
    ds_read_b64_tr_b16 v[172:173], v107 offset:4096
    ds_read_b64_tr_b16 v[174:175], v107 offset:5120
    s_bitcmp1_b32 s34, s31
    s_cbranch_scc0 L_qpd1_e
    s_add_u32 m0, s45, s30
    s_add_u32 m0, m0, 0x4000
    s_nop 0
    buffer_load_dwordx4 v100, s[16:19], s39 offen offset:0  lds
    buffer_load_dwordx4 v101, s[16:19], s39 offen offset:1024  lds
    buffer_load_dwordx4 v102, s[16:19], s39 offen offset:2048  lds
    buffer_load_dwordx4 v103, s[16:19], s39 offen offset:3072  lds
    s_add_u32 s64, s64, 1
    s_and_b32 s64, s64, 7
    s_lshl_b32 s38, s64, 19
    s_add_u32 s38, s38, s65
    s_lshl_b32 s39, s64, 7
    s_add_u32 s39, s39, s66
L_qpd1_e:
    s_branch L_qp_mid
L_qp_loop:
    v_mfma_f32_32x32x16_bf16 v[0:15], v[176:179], v[216:219], v[0:15]
    ds_read_b128 v[208:211], v108
    ds_read_b64_tr_b16 v[144:145], v104 offset:0
    ds_read_b64_tr_b16 v[146:147], v104 offset:1024
    v_mfma_f32_32x32x16_bf16 v[16:31], v[180:183], v[216:219], v[16:31]
    ds_read_b64_tr_b16 v[148:149], v105 offset:0
    ds_read_b64_tr_b16 v[150:151], v105 offset:1024
    v_mfma_f32_32x32x16_bf16 v[32:47], v[184:187], v[216:219], v[32:47]
    ds_read_b64_tr_b16 v[152:153], v106 offset:0
    ds_read_b64_tr_b16 v[154:155], v106 offset:1024
    v_mfma_f32_32x32x16_bf16 v[48:63], v[188:191], v[216:219], v[48:63]
    ds_read_b64_tr_b16 v[156:157], v107 offset:0
    ds_read_b64_tr_b16 v[158:159], v107 offset:1024
    s_and_b32 s45, s33, 7
    s_lshl_b32 s45, s45, 15
    s_lshr_b32 s33, s33, 4
    s_bitcmp1_b32 s34, s31
    s_cbranch_scc0 L_qpd0_l
    s_add_u32 m0, s45, s30
    s_nop 0
    buffer_load_dwordx4 v96, s[12:15], s38 offen offset:0  lds
    buffer_load_dwordx4 v97, s[12:15], s38 offen offset:1024  lds
    buffer_load_dwordx4 v98, s[12:15], s38 offen offset:2048  lds
    buffer_load_dwordx4 v99, s[12:15], s38 offen offset:3072  lds
L_qpd0_l:
    v_mfma_f32_32x32x16_bf16 v[0:15], v[192:195], v[220:223], v[0:15]
    ds_read_b128 v[212:215], v109
    ds_read_b64_tr_b16 v[160:161], v104 offset:4096
    ds_read_b64_tr_b16 v[162:163], v104 offset:5120
    v_mfma_f32_32x32x16_bf16 v[16:31], v[196:199], v[220:223], v[16:31]
    ds_read_b64_tr_b16 v[164:165], v105 offset:4096
    ds_read_b64_tr_b16 v[166:167], v105 offset:5120
    v_mfma_f32_32x32x16_bf16 v[32:47], v[200:203], v[220:223], v[32:47]
    ds_read_b64_tr_b16 v[168:169], v106 offset:4096
    ds_read_b64_tr_b16 v[170:171], v106 offset:5120
    v_mfma_f32_32x32x16_bf16 v[48:63], v[204:207], v[220:223], v[48:63]
    ds_read_b64_tr_b16 v[172:173], v107 offset:4096
    ds_read_b64_tr_b16 v[174:175], v107 offset:5120
    s_bitcmp1_b32 s34, s31
    s_cbranch_scc0 L_qpd1_l
    s_add_u32 m0, s45, s30
    s_add_u32 m0, m0, 0x4000
    s_nop 0
    buffer_load_dwordx4 v100, s[16:19], s39 offen offset:0  lds
    buffer_load_dwordx4 v101, s[16:19], s39 offen offset:1024  lds
    buffer_load_dwordx4 v102, s[16:19], s39 offen offset:2048  lds
    buffer_load_dwordx4 v103, s[16:19], s39 offen offset:3072  lds
    s_add_u32 s64, s64, 1
    s_and_b32 s64, s64, 7
    s_lshl_b32 s38, s64, 19
    s_add_u32 s38, s38, s65
    s_lshl_b32 s39, s64, 7
    s_add_u32 s39, s39, s66
L_qpd1_l:
L_qp_mid:
    s_waitcnt lgkmcnt(15)
    v_mfma_f32_32x32x16_bf16 v[0:15], v[144:147], v[208:211], v[0:15]
    ds_read_b128 v[216:219], v110
    ds_read_b64_tr_b16 v[176:177], v104 offset:8192
    ds_read_b64_tr_b16 v[178:179], v104 offset:9216
    s_waitcnt lgkmcnt(15)
    v_mfma_f32_32x32x16_bf16 v[16:31], v[148:151], v[208:211], v[16:31]
    ds_read_b64_tr_b16 v[180:181], v105 offset:8192
    ds_read_b64_tr_b16 v[182:183], v105 offset:9216
    ds_read_b64_tr_b16 v[184:185], v106 offset:8192
    s_waitcnt lgkmcnt(15)
    v_mfma_f32_32x32x16_bf16 v[32:47], v[152:155], v[208:211], v[32:47]
    ds_read_b64_tr_b16 v[186:187], v106 offset:9216
    ds_read_b64_tr_b16 v[188:189], v107 offset:8192
    ds_read_b64_tr_b16 v[190:191], v107 offset:9216
    v_mfma_f32_32x32x16_bf16 v[48:63], v[156:159], v[208:211], v[48:63]
    ds_read_b128 v[220:223], v111
    ds_read_b64_tr_b16 v[192:193], v104 offset:12288
    ds_read_b64_tr_b16 v[194:195], v104 offset:13312
    s_and_b32 s46, s78, 7
    s_lshl_b32 s46, s46, 15
    s_lshr_b32 s78, s78, 4
    s_bitcmp1_b32 s77, s31
    s_cbranch_scc0 L_qpd2_e
    s_add_u32 m0, s46, s30
    s_nop 0
    buffer_load_dwordx4 v246, s[4:7], s43 offen offset:0 nt lds
    buffer_load_dwordx4 v247, s[4:7], s43 offen offset:1024 nt lds
    buffer_load_dwordx4 v248, s[4:7], s43 offen offset:2048 nt lds
    buffer_load_dwordx4 v249, s[4:7], s43 offen offset:3072 nt lds
L_qpd2_e:
    s_waitcnt lgkmcnt(15)
    v_mfma_f32_32x32x16_bf16 v[0:15], v[160:163], v[212:215], v[0:15]
    ds_read_b64_tr_b16 v[196:197], v105 offset:12288
    ds_read_b64_tr_b16 v[198:199], v105 offset:13312
    ds_read_b64_tr_b16 v[200:201], v106 offset:12288
    v_mfma_f32_32x32x16_bf16 v[16:31], v[164:167], v[212:215], v[16:31]
    ds_read_b64_tr_b16 v[202:203], v106 offset:13312
    ds_read_b64_tr_b16 v[204:205], v107 offset:12288
    ds_read_b64_tr_b16 v[206:207], v107 offset:13312
    s_waitcnt lgkmcnt(15)
    v_mfma_f32_32x32x16_bf16 v[32:47], v[168:171], v[212:215], v[32:47]
    s_and_b32 s44, s32, 7
    s_lshl_b32 s44, s44, 15
    s_lshr_b32 s32, s32, 4
    s_sub_u32 s37, s44, s36
    s_mov_b32 s36, s44
    v_add_u32 v104, s37, v104
    v_add_u32 v105, s37, v105
    v_add_u32 v106, s37, v106
    v_add_u32 v107, s37, v107
    v_add_u32 v108, s37, v108
    v_add_u32 v109, s37, v109
    v_add_u32 v110, s37, v110
    v_add_u32 v111, s37, v111
    v_mfma_f32_32x32x16_bf16 v[48:63], v[172:175], v[212:215], v[48:63]
    s_bitcmp1_b32 s77, s31
    s_cbranch_scc0 L_qpd3_e
    s_add_u32 m0, s46, s30
    s_add_u32 m0, m0, 0x4000
    s_nop 0
    buffer_load_dwordx4 v250, s[8:11], s43 offen offset:0 nt lds
    buffer_load_dwordx4 v250, s[8:11], s43 offen offset:1024 nt lds
    buffer_load_dwordx4 v250, s[8:11], s43 offen offset:2048 nt lds
    buffer_load_dwordx4 v250, s[8:11], s43 offen offset:3072 nt lds
    s_add_u32 s43, s43, 0x4000
    s_cmp_eq_u32 s31, 5
    s_cselect_b32 s44, s50, 0
    s_add_u32 s43, s43, s44
L_qpd3_e:
    s_cmp_eq_u32 s31, 7
    s_cbranch_scc1 L_qp_done
    s_waitcnt vmcnt(8) lgkmcnt(0)
    s_barrier
    s_add_u32 s31, s31, 1
    s_branch L_qp_loop
L_qp_done:
    s_mov_b32 s44, 0x3e0293ee
    v_mfma_f32_32x32x16_bf16 v[0:15], v[176:179], v[216:219], v[0:15]
    s_waitcnt lgkmcnt(6)
    v_mfma_f32_32x32x16_bf16 v[0:15], v[192:195], v[220:223], v[0:15]
    v_mfma_f32_32x32x16_bf16 v[16:31], v[180:183], v[216:219], v[16:31]
    s_nop 10
    v_pk_mul_f32 v[0:1], v[0:1], s[44:45] op_sel_hi:[1,0]
    v_pk_mul_f32 v[2:3], v[2:3], s[44:45] op_sel_hi:[1,0]
    v_pk_mul_f32 v[4:5], v[4:5], s[44:45] op_sel_hi:[1,0]
    v_pk_mul_f32 v[6:7], v[6:7], s[44:45] op_sel_hi:[1,0]
    v_cvt_pk_bf16_f32 v64, v0, v1
    v_cvt_pk_bf16_f32 v65, v2, v3
    v_cvt_pk_bf16_f32 v66, v4, v5
    v_cvt_pk_bf16_f32 v67, v6, v7
    s_waitcnt lgkmcnt(4)
    v_mfma_f32_32x32x16_bf16 v[16:31], v[196:199], v[220:223], v[16:31]
    v_pk_mul_f32 v[8:9], v[8:9], s[44:45] op_sel_hi:[1,0]
    v_pk_mul_f32 v[10:11], v[10:11], s[44:45] op_sel_hi:[1,0]
    v_pk_mul_f32 v[12:13], v[12:13], s[44:45] op_sel_hi:[1,0]
    v_pk_mul_f32 v[14:15], v[14:15], s[44:45] op_sel_hi:[1,0]
    v_cvt_pk_bf16_f32 v68, v8, v9
    v_cvt_pk_bf16_f32 v69, v10, v11
    v_cvt_pk_bf16_f32 v70, v12, v13
    v_cvt_pk_bf16_f32 v71, v14, v15
    v_mfma_f32_32x32x16_bf16 v[32:47], v[184:187], v[216:219], v[32:47]
    s_nop 2
    v_pk_mul_f32 v[16:17], v[16:17], s[44:45] op_sel_hi:[1,0]
    v_pk_mul_f32 v[18:19], v[18:19], s[44:45] op_sel_hi:[1,0]
    v_pk_mul_f32 v[20:21], v[20:21], s[44:45] op_sel_hi:[1,0]
    v_pk_mul_f32 v[22:23], v[22:23], s[44:45] op_sel_hi:[1,0]
    v_cvt_pk_bf16_f32 v72, v16, v17
    v_cvt_pk_bf16_f32 v73, v18, v19
    v_cvt_pk_bf16_f32 v74, v20, v21
    v_cvt_pk_bf16_f32 v75, v22, v23
    s_waitcnt lgkmcnt(2)
    v_mfma_f32_32x32x16_bf16 v[32:47], v[200:203], v[220:223], v[32:47]
    v_pk_mul_f32 v[24:25], v[24:25], s[44:45] op_sel_hi:[1,0]
    v_pk_mul_f32 v[26:27], v[26:27], s[44:45] op_sel_hi:[1,0]
    v_pk_mul_f32 v[28:29], v[28:29], s[44:45] op_sel_hi:[1,0]
    v_pk_mul_f32 v[30:31], v[30:31], s[44:45] op_sel_hi:[1,0]
    v_cvt_pk_bf16_f32 v76, v24, v25
    v_cvt_pk_bf16_f32 v77, v26, v27
    v_cvt_pk_bf16_f32 v78, v28, v29
    v_cvt_pk_bf16_f32 v79, v30, v31
    v_mfma_f32_32x32x16_bf16 v[48:63], v[188:191], v[216:219], v[48:63]
    s_nop 2
    v_pk_mul_f32 v[32:33], v[32:33], s[44:45] op_sel_hi:[1,0]
    v_pk_mul_f32 v[34:35], v[34:35], s[44:45] op_sel_hi:[1,0]
    v_pk_mul_f32 v[36:37], v[36:37], s[44:45] op_sel_hi:[1,0]
    v_pk_mul_f32 v[38:39], v[38:39], s[44:45] op_sel_hi:[1,0]
    v_cvt_pk_bf16_f32 v80, v32, v33
    v_cvt_pk_bf16_f32 v81, v34, v35
    v_cvt_pk_bf16_f32 v82, v36, v37
    v_cvt_pk_bf16_f32 v83, v38, v39
    s_waitcnt lgkmcnt(0)
    v_mfma_f32_32x32x16_bf16 v[48:63], v[204:207], v[220:223], v[48:63]
    v_pk_mul_f32 v[40:41], v[40:41], s[44:45] op_sel_hi:[1,0]
    v_pk_mul_f32 v[42:43], v[42:43], s[44:45] op_sel_hi:[1,0]
    v_pk_mul_f32 v[44:45], v[44:45], s[44:45] op_sel_hi:[1,0]
    v_pk_mul_f32 v[46:47], v[46:47], s[44:45] op_sel_hi:[1,0]
    v_cvt_pk_bf16_f32 v84, v40, v41
    v_cvt_pk_bf16_f32 v85, v42, v43
    v_cvt_pk_bf16_f32 v86, v44, v45
    v_cvt_pk_bf16_f32 v87, v46, v47
    s_nop 3
    v_pk_mul_f32 v[48:49], v[48:49], s[44:45] op_sel_hi:[1,0]
    v_pk_mul_f32 v[50:51], v[50:51], s[44:45] op_sel_hi:[1,0]
    v_pk_mul_f32 v[52:53], v[52:53], s[44:45] op_sel_hi:[1,0]
    v_pk_mul_f32 v[54:55], v[54:55], s[44:45] op_sel_hi:[1,0]
    v_cvt_pk_bf16_f32 v88, v48, v49
    v_cvt_pk_bf16_f32 v89, v50, v51
    v_cvt_pk_bf16_f32 v90, v52, v53
    v_cvt_pk_bf16_f32 v91, v54, v55
    v_pk_mul_f32 v[56:57], v[56:57], s[44:45] op_sel_hi:[1,0]
    v_pk_mul_f32 v[58:59], v[58:59], s[44:45] op_sel_hi:[1,0]
    v_pk_mul_f32 v[60:61], v[60:61], s[44:45] op_sel_hi:[1,0]
    v_pk_mul_f32 v[62:63], v[62:63], s[44:45] op_sel_hi:[1,0]
    v_cvt_pk_bf16_f32 v92, v56, v57
    v_cvt_pk_bf16_f32 v93, v58, v59
    v_cvt_pk_bf16_f32 v94, v60, v61
    v_cvt_pk_bf16_f32 v95, v62, v63
    v_mfma_f32_32x32x16_bf16 v[0:15], v[128:131], v[128:131], 0
    v_mfma_f32_32x32x16_bf16 v[16:31], v[128:131], v[128:131], 0
    v_mfma_f32_32x32x16_bf16 v[32:47], v[128:131], v[128:131], 0
    v_mfma_f32_32x32x16_bf16 v[48:63], v[128:131], v[128:131], 0
    s_cmp_eq_u32 s26, 0
    s_cselect_b32 s36, 0, 65536
    s_mov_b32 s44, 0x210210
    s_cselect_b32 s32, 0x11021021, s44
    s_mov_b32 s40, -1.0
    s_mov_b32 s41, 0xff7fffff
    s_mov_b32 s42, 0
    s_cmp_eq_u32 s24, 0
    s_cbranch_scc0 L_na
    s_waitcnt vmcnt(0)
    s_add_u32 s44, s94, s93
    v_mov_b32 v238, 1
    s_mov_b64 exec, 1
    buffer_store_byte v238, off, s[84:87], s44 sc1
    s_mov_b64 exec, -1
L_na:
    s_cmp_eq_u32 s24, 0
    s_cselect_b32 s71, 6, 63
    s_mov_b32 s31, 0
    s_waitcnt vmcnt(8)
    s_barrier
    ds_read_b128 v[144:147], v224 offset:0
    ds_read_b128 v[148:151], v225 offset:0
    ds_read_b128 v[152:155], v226 offset:0
    ds_read_b128 v[156:159], v227 offset:0
    ds_read_b128 v[160:163], v228 offset:0
    ds_read_b128 v[164:167], v229 offset:0
    ds_read_b128 v[168:171], v230 offset:0
    ds_read_b128 v[172:175], v231 offset:0
    s_branch L_at_mid
L_at_loop:
    v_mfma_f32_32x32x16_bf16 v[0:15], v[176:179], v[216:219], v[0:15]
    ds_read_b128 v[144:147], v224 offset:0
    v_mfma_f32_32x32x16_bf16 v[16:31], v[180:183], v[216:219], v[16:31]
    ds_read_b128 v[148:151], v225 offset:0
    v_mfma_f32_32x32x16_bf16 v[32:47], v[184:187], v[216:219], v[32:47]
    ds_read_b128 v[152:155], v226 offset:0
    v_mfma_f32_32x32x16_bf16 v[48:63], v[188:191], v[216:219], v[48:63]
    ds_read_b128 v[156:159], v227 offset:0
    v_mfma_f32_32x32x16_bf16 v[0:15], v[192:195], v[220:223], v[0:15]
    ds_read_b128 v[160:163], v228 offset:0
    v_mfma_f32_32x32x16_bf16 v[16:31], v[196:199], v[220:223], v[16:31]
    ds_read_b128 v[164:167], v229 offset:0
    v_mfma_f32_32x32x16_bf16 v[32:47], v[200:203], v[220:223], v[32:47]
    ds_read_b128 v[168:171], v230 offset:0
    v_mfma_f32_32x32x16_bf16 v[48:63], v[204:207], v[220:223], v[48:63]
    ds_read_b128 v[172:175], v231 offset:0
L_at_mid:
    s_cmp_eq_u32 s31, s71
    s_cbranch_scc0 L_hk
    buffer_load_dwordx4 v[244:247], off, s[84:87], s95 sc1
L_hk:
    s_waitcnt lgkmcnt(7)
    v_mfma_f32_32x32x16_bf16 v[96:111], v[144:147], v[64:67], v[128:143]
    ds_read_b128 v[144:147], v224 offset:8192
    ds_read_b64_tr_b16 v[176:177], v232 offset:0
    ds_read_b64_tr_b16 v[178:179], v232 offset:2048
    s_waitcnt lgkmcnt(9)
    v_mfma_f32_32x32x16_bf16 v[96:111], v[148:151], v[68:71], v[96:111]
    ds_read_b128 v[148:151], v225 offset:8192
    ds_read_b64_tr_b16 v[180:181], v233 offset:0
    ds_read_b64_tr_b16 v[182:183], v233 offset:2048
    s_waitcnt lgkmcnt(11)
    v_mfma_f32_32x32x16_bf16 v[96:111], v[152:155], v[72:75], v[96:111]
    ds_read_b128 v[152:155], v226 offset:8192
    ds_read_b64_tr_b16 v[184:185], v234 offset:0
    ds_read_b64_tr_b16 v[186:187], v234 offset:2048
    s_waitcnt lgkmcnt(13)
    v_mfma_f32_32x32x16_bf16 v[96:111], v[156:159], v[76:79], v[96:111]
    ds_read_b128 v[156:159], v227 offset:8192
    ds_read_b64_tr_b16 v[188:189], v235 offset:0
    ds_read_b64_tr_b16 v[190:191], v235 offset:2048
    s_waitcnt lgkmcnt(15)
    v_mfma_f32_32x32x16_bf16 v[96:111], v[160:163], v[80:83], v[96:111]
    ds_read_b128 v[160:163], v228 offset:8192
    ds_read_b64_tr_b16 v[192:193], v232 offset:4096
    ds_read_b64_tr_b16 v[194:195], v232 offset:6144
    s_waitcnt lgkmcnt(15)
    v_mfma_f32_32x32x16_bf16 v[96:111], v[164:167], v[84:87], v[96:111]
    ds_read_b128 v[164:167], v229 offset:8192
    ds_read_b64_tr_b16 v[196:197], v233 offset:4096
    ds_read_b64_tr_b16 v[198:199], v233 offset:6144
    v_mfma_f32_32x32x16_bf16 v[96:111], v[168:171], v[88:91], v[96:111]
    ds_read_b128 v[168:171], v230 offset:8192
    ds_read_b64_tr_b16 v[200:201], v234 offset:4096
    ds_read_b64_tr_b16 v[202:203], v234 offset:6144
    v_mfma_f32_32x32x16_bf16 v[96:111], v[172:175], v[92:95], v[96:111]
    ds_read_b128 v[172:175], v231 offset:8192
    ds_read_b64_tr_b16 v[204:205], v235 offset:4096
    ds_read_b64_tr_b16 v[206:207], v235 offset:6144
    s_waitcnt lgkmcnt(15)
    v_mfma_f32_32x32x16_bf16 v[112:127], v[144:147], v[64:67], v[128:143]
    s_and_b32 s44, s32, 7
    s_lshl_b32 s44, s44, 15
    s_lshr_b32 s32, s32, 4
    s_sub_u32 s37, s44, s36
    s_mov_b32 s36, s44
    v_add_u32 v224, s37, v224
    v_add_u32 v225, s37, v225
    v_add_u32 v226, s37, v226
    v_add_u32 v227, s37, v227
    v_add_u32 v228, s37, v228
    v_add_u32 v229, s37, v229
    v_add_u32 v230, s37, v230
    v_add_u32 v231, s37, v231
    v_mfma_f32_32x32x16_bf16 v[112:127], v[148:151], v[68:71], v[112:127]
    v_mfma_f32_32x32x16_bf16 v[112:127], v[152:155], v[72:75], v[112:127]
    v_exp_f32 v238, v96
    v_exp_f32 v239, v97
    v_add_f32 v236, v237, v238
    v_add_f32 v236, v236, v239
    v_cvt_pk_bf16_f32 v208, v238, v239
    v_exp_f32 v240, v98
    v_exp_f32 v241, v99
    s_waitcnt lgkmcnt(14)
    v_mfma_f32_32x32x16_bf16 v[112:127], v[156:159], v[76:79], v[112:127]
    v_add_f32 v236, v236, v240
    v_add_f32 v236, v236, v241
    v_cvt_pk_bf16_f32 v209, v240, v241
    v_exp_f32 v238, v100
    v_exp_f32 v239, v101
    v_add_f32 v236, v236, v238
    v_add_f32 v236, v236, v239
    v_cvt_pk_bf16_f32 v210, v238, v239
    s_waitcnt lgkmcnt(11)
    v_mfma_f32_32x32x16_bf16 v[112:127], v[160:163], v[80:83], v[112:127]
    v_exp_f32 v240, v102
    v_exp_f32 v241, v103
    v_add_f32 v236, v236, v240
    v_add_f32 v236, v236, v241
    v_cvt_pk_bf16_f32 v211, v240, v241
    v_exp_f32 v238, v104
    v_exp_f32 v239, v105
    s_waitcnt lgkmcnt(8)
    v_mfma_f32_32x32x16_bf16 v[112:127], v[164:167], v[84:87], v[112:127]
    v_add_f32 v236, v236, v238
    v_add_f32 v236, v236, v239
    v_cvt_pk_bf16_f32 v212, v238, v239
    v_exp_f32 v240, v106
    v_exp_f32 v241, v107
    v_add_f32 v236, v236, v240
    v_add_f32 v236, v236, v241
    v_cvt_pk_bf16_f32 v213, v240, v241
    s_waitcnt lgkmcnt(5)
    v_mfma_f32_32x32x16_bf16 v[112:127], v[168:171], v[88:91], v[112:127]
    v_exp_f32 v238, v108
    v_exp_f32 v239, v109
    v_add_f32 v236, v236, v238
    v_add_f32 v236, v236, v239
    v_cvt_pk_bf16_f32 v214, v238, v239
    s_waitcnt lgkmcnt(2)
    v_mfma_f32_32x32x16_bf16 v[112:127], v[172:175], v[92:95], v[112:127]
    v_exp_f32 v240, v110
    v_exp_f32 v241, v111
    v_add_f32 v236, v236, v240
    v_add_f32 v236, v236, v241
    v_cvt_pk_bf16_f32 v215, v240, v241
    v_cmp_nge_f32 vcc, s40, v236
    s_cbranch_vccnz L_fb_a
L_fbret_a:
    v_mfma_f32_32x32x16_bf16 v[0:15], v[176:179], v[208:211], v[0:15]
    ds_read_b64_tr_b16 v[176:177], v232 offset:8192
    ds_read_b64_tr_b16 v[178:179], v232 offset:10240
    v_mfma_f32_32x32x16_bf16 v[16:31], v[180:183], v[208:211], v[16:31]
    ds_read_b64_tr_b16 v[180:181], v233 offset:8192
    ds_read_b64_tr_b16 v[182:183], v233 offset:10240
    v_exp_f32 v238, v112
    v_exp_f32 v239, v113
    v_add_f32 v237, v236, v238
    v_add_f32 v237, v237, v239
    v_cvt_pk_bf16_f32 v216, v238, v239
    v_exp_f32 v240, v114
    v_mfma_f32_32x32x16_bf16 v[32:47], v[184:187], v[208:211], v[32:47]
    ds_read_b64_tr_b16 v[184:185], v234 offset:8192
    ds_read_b64_tr_b16 v[186:187], v234 offset:10240
    v_exp_f32 v241, v115
    v_add_f32 v237, v237, v240
    v_add_f32 v237, v237, v241
    v_cvt_pk_bf16_f32 v217, v240, v241
    v_exp_f32 v238, v116
    v_exp_f32 v239, v117
    v_mfma_f32_32x32x16_bf16 v[48:63], v[188:191], v[208:211], v[48:63]
    ds_read_b64_tr_b16 v[188:189], v235 offset:8192
    ds_read_b64_tr_b16 v[190:191], v235 offset:10240
    v_add_f32 v237, v237, v238
    v_add_f32 v237, v237, v239
    v_cvt_pk_bf16_f32 v218, v238, v239
    v_exp_f32 v240, v118
    v_exp_f32 v241, v119
    v_add_f32 v237, v237, v240
    v_mfma_f32_32x32x16_bf16 v[0:15], v[192:195], v[212:215], v[0:15]
    ds_read_b64_tr_b16 v[192:193], v232 offset:12288
    ds_read_b64_tr_b16 v[194:195], v232 offset:14336
    v_add_f32 v237, v237, v241
    v_cvt_pk_bf16_f32 v219, v240, v241
    v_exp_f32 v238, v120
    v_exp_f32 v239, v121
    v_add_f32 v237, v237, v238
    v_mfma_f32_32x32x16_bf16 v[16:31], v[196:199], v[212:215], v[16:31]
    ds_read_b64_tr_b16 v[196:197], v233 offset:12288
    ds_read_b64_tr_b16 v[198:199], v233 offset:14336
    v_add_f32 v237, v237, v239
    v_cvt_pk_bf16_f32 v220, v238, v239
    v_exp_f32 v240, v122
    v_exp_f32 v241, v123
    v_add_f32 v237, v237, v240
    v_add_f32 v237, v237, v241
    v_mfma_f32_32x32x16_bf16 v[32:47], v[200:203], v[212:215], v[32:47]
    ds_read_b64_tr_b16 v[200:201], v234 offset:12288
    ds_read_b64_tr_b16 v[202:203], v234 offset:14336
    v_cvt_pk_bf16_f32 v221, v240, v241
    v_exp_f32 v238, v124
    v_exp_f32 v239, v125
    v_add_f32 v237, v237, v238
    v_add_f32 v237, v237, v239
    v_cvt_pk_bf16_f32 v222, v238, v239
    s_waitcnt lgkmcnt(14)
    v_mfma_f32_32x32x16_bf16 v[48:63], v[204:207], v[212:215], v[48:63]
    ds_read_b64_tr_b16 v[204:205], v235 offset:12288
    ds_read_b64_tr_b16 v[206:207], v235 offset:14336
    v_exp_f32 v240, v126
    v_exp_f32 v241, v127
    v_add_f32 v237, v237, v240
    v_add_f32 v237, v237, v241
    v_cvt_pk_bf16_f32 v223, v240, v241
    v_add_u32 v232, s37, v232
    v_add_u32 v233, s37, v233
    v_add_u32 v234, s37, v234
    v_add_u32 v235, s37, v235
    v_cmp_nge_f32 vcc, s40, v237
    s_cbranch_vccnz L_fb_b
L_fbret_b:
    s_cmp_lt_u32 s31, s71
    s_cbranch_scc0 L_at_nw
    s_waitcnt vmcnt(0)
L_at_nw:
    s_waitcnt lgkmcnt(0)
    s_barrier
    s_add_u32 s31, s31, 1
    s_cmp_lt_u32 s31, 8
    s_cbranch_scc1 L_at_loop
    v_mfma_f32_32x32x16_bf16 v[0:15], v[176:179], v[216:219], v[0:15]
    v_mfma_f32_32x32x16_bf16 v[16:31], v[180:183], v[216:219], v[16:31]
    v_mfma_f32_32x32x16_bf16 v[32:47], v[184:187], v[216:219], v[32:47]
    v_mfma_f32_32x32x16_bf16 v[48:63], v[188:191], v[216:219], v[48:63]
    v_mfma_f32_32x32x16_bf16 v[0:15], v[192:195], v[220:223], v[0:15]
    v_mfma_f32_32x32x16_bf16 v[16:31], v[196:199], v[220:223], v[16:31]
    v_mfma_f32_32x32x16_bf16 v[32:47], v[200:203], v[220:223], v[32:47]
    v_mfma_f32_32x32x16_bf16 v[48:63], v[204:207], v[220:223], v[48:63]
    s_nop 7
    s_cmp_eq_u32 s26, 0
    s_cbranch_scc0 L_y_tail
    s_cmp_eq_u32 s25, 0
    s_cbranch_scc0 L_ac_d
    s_mov_b32 s96, 400000
    s_waitcnt vmcnt(0)
    s_branch L_ac_c
L_ac_l:
    buffer_load_dwordx4 v[244:247], off, s[84:87], s95 sc1
    s_waitcnt vmcnt(0)
L_ac_c:
    v_and_b32 v238, v244, v245
    v_and_b32 v239, v246, v247
    v_and_b32 v238, v238, v239
    s_nop 0
    v_readfirstlane_b32 s44, v238
    s_cmp_eq_u32 s44, 0x01010101
    s_cbranch_scc1 L_ac_d
    s_sub_u32 s96, s96, 1
    s_cbranch_scc0 L_ac_l
L_ac_d:
    v_and_b32 v238, 63, v255
    v_lshrrev_b32 v239, 4, v238
    s_lshl_b32 s44, s25, 12
    v_lshlrev_b32 v240, 8, v239
    v_add_u32 v240, s44, v240
    v_and_b32 v241, 15, v238
    v_add_u32 v243, 0, v239
    v_xor_b32 v243, v243, v241
    v_lshl_add_u32 v246, v243, 4, v240
    v_add_u32 v243, 4, v239
    v_xor_b32 v243, v243, v241
    v_lshl_add_u32 v247, v243, 4, v240
    v_add_u32 v243, 8, v239
    v_xor_b32 v243, v243, v241
    v_lshl_add_u32 v248, v243, 4, v240
    v_add_u32 v243, 12, v239
    v_xor_b32 v243, v243, v241
    v_lshl_add_u32 v249, v243, 4, v240
    v_lshlrev_b32 v243, 2, v239
    v_xor_b32 v243, v243, v241
    v_lshl_add_u32 v250, v243, 4, v240
    v_and_b32 v238, 63, v255
    v_lshrrev_b32 v239, 4, v238
    v_and_b32 v241, 15, v238
    v_lshlrev_b32 v243, 2, v239
    v_xor_b32 v243, v243, v241
    v_lshlrev_b32 v243, 4, v243
    v_lshl_add_u32 v243, v239, 10, v243
    s_lshl_b32 s44, s25, 14
    v_add_u32 v224, s44, v243
    v_add_u32 v225, 3072, v224
    v_add_u32 v226, 6144, v224
    v_add_u32 v227, 9216, v224
    v_lshlrev_b32 v228, 4, v238
    v_lshrrev_b32 v240, 5, v238
    v_bfe_u32 v241, v238, 2, 2
    v_and_b32 v242, 3, v238
    v_lshl_add_u32 v243, v240, 2, v241
    v_lshlrev_b32 v243, 8, v243
    v_and_b32 v229, 1, v239
    v_lshl_add_u32 v243, v229, 5, v243
    v_lshrrev_b32 v229, 1, v242
    v_lshl_add_u32 v243, v229, 4, v243
    v_and_b32 v229, 1, v242
    v_lshl_add_u32 v243, v229, 3, v243
    v_xor_b32 v229, 0, v241
    v_lshl_add_u32 v232, v229, 6, v243
    v_xor_b32 v229, 1, v241
    v_lshl_add_u32 v233, v229, 6, v243
    v_xor_b32 v229, 2, v241
    v_lshl_add_u32 v234, v229, 6, v243
    v_xor_b32 v229, 3, v241
    v_lshl_add_u32 v235, v229, 6, v243
    s_mov_b32 s99, 0
    s_lshl_b32 s44, s27, 1
    s_lshr_b32 s44, 0x4924, s44
    s_and_b32 s44, s44, 3
    s_mov_b32 s98, 0x321
    s_cmp_eq_u32 s44, 1
    s_cselect_b32 s98, 0x132, s98
    s_cmp_eq_u32 s44, 2
    s_cselect_b32 s98, 0x213, s98
    s_lshl_b32 s44, s27, 5
    s_add_u32 s44, s44, s79
    s_add_u32 s44, s44, s48
    s_add_u32 s44, s44, 16
    s_lshl_b32 s43, s44, 17
    s_add_u32 s43, s43, 0x8000
    v_mov_b32 v238, v237
    s_nop 1
    v_permlane32_swap_b32 v237, v238
    v_add_f32 v237, v237, v238
    v_rcp_f32 v238, v237
    s_lshl_b32 s44, s28, 13
    s_add_u32 s44, s44, s97
    v_and_b32 v239, 63, v255
    v_lshlrev_b32 v239, 4, v239
    v_pk_mul_f32 v[0:1], v[0:1], v[238:239] op_sel_hi:[1,0]
    v_pk_mul_f32 v[2:3], v[2:3], v[238:239] op_sel_hi:[1,0]
    v_pk_mul_f32 v[4:5], v[4:5], v[238:239] op_sel_hi:[1,0]
    v_pk_mul_f32 v[6:7], v[6:7], v[238:239] op_sel_hi:[1,0]
    v_cvt_pk_bf16_f32 v144, v0, v1
    v_cvt_pk_bf16_f32 v145, v2, v3
    v_cvt_pk_bf16_f32 v146, v4, v5
    v_cvt_pk_bf16_f32 v147, v6, v7
    buffer_store_dwordx4 v[144:147], v239, s[20:23], s44 offen offset:0 sc1
    v_pk_mul_f32 v[8:9], v[8:9], v[238:239] op_sel_hi:[1,0]
    v_pk_mul_f32 v[10:11], v[10:11], v[238:239] op_sel_hi:[1,0]
    v_pk_mul_f32 v[12:13], v[12:13], v[238:239] op_sel_hi:[1,0]
    v_pk_mul_f32 v[14:15], v[14:15], v[238:239] op_sel_hi:[1,0]
    v_cvt_pk_bf16_f32 v148, v8, v9
    v_cvt_pk_bf16_f32 v149, v10, v11
    v_cvt_pk_bf16_f32 v150, v12, v13
    v_cvt_pk_bf16_f32 v151, v14, v15
    buffer_store_dwordx4 v[148:151], v239, s[20:23], s44 offen offset:1024 sc1
    v_pk_mul_f32 v[16:17], v[16:17], v[238:239] op_sel_hi:[1,0]
    v_pk_mul_f32 v[18:19], v[18:19], v[238:239] op_sel_hi:[1,0]
    v_pk_mul_f32 v[20:21], v[20:21], v[238:239] op_sel_hi:[1,0]
    v_pk_mul_f32 v[22:23], v[22:23], v[238:239] op_sel_hi:[1,0]
    v_cvt_pk_bf16_f32 v152, v16, v17
    v_cvt_pk_bf16_f32 v153, v18, v19
    v_cvt_pk_bf16_f32 v154, v20, v21
    v_cvt_pk_bf16_f32 v155, v22, v23
    buffer_store_dwordx4 v[152:155], v239, s[20:23], s44 offen offset:2048 sc1
    v_pk_mul_f32 v[24:25], v[24:25], v[238:239] op_sel_hi:[1,0]
    v_pk_mul_f32 v[26:27], v[26:27], v[238:239] op_sel_hi:[1,0]
    v_pk_mul_f32 v[28:29], v[28:29], v[238:239] op_sel_hi:[1,0]
    v_pk_mul_f32 v[30:31], v[30:31], v[238:239] op_sel_hi:[1,0]
    v_cvt_pk_bf16_f32 v156, v24, v25
    v_cvt_pk_bf16_f32 v157, v26, v27
    v_cvt_pk_bf16_f32 v158, v28, v29
    v_cvt_pk_bf16_f32 v159, v30, v31
    buffer_store_dwordx4 v[156:159], v239, s[20:23], s44 offen offset:3072 sc1
    v_pk_mul_f32 v[32:33], v[32:33], v[238:239] op_sel_hi:[1,0]
    v_pk_mul_f32 v[34:35], v[34:35], v[238:239] op_sel_hi:[1,0]
    v_pk_mul_f32 v[36:37], v[36:37], v[238:239] op_sel_hi:[1,0]
    v_pk_mul_f32 v[38:39], v[38:39], v[238:239] op_sel_hi:[1,0]
    v_cvt_pk_bf16_f32 v160, v32, v33
    v_cvt_pk_bf16_f32 v161, v34, v35
    v_cvt_pk_bf16_f32 v162, v36, v37
    v_cvt_pk_bf16_f32 v163, v38, v39
    s_add_u32 s44, s44, 4096
    buffer_store_dwordx4 v[160:163], v239, s[20:23], s44 offen offset:0 sc1
    v_pk_mul_f32 v[40:41], v[40:41], v[238:239] op_sel_hi:[1,0]
    v_pk_mul_f32 v[42:43], v[42:43], v[238:239] op_sel_hi:[1,0]
    v_pk_mul_f32 v[44:45], v[44:45], v[238:239] op_sel_hi:[1,0]
    v_pk_mul_f32 v[46:47], v[46:47], v[238:239] op_sel_hi:[1,0]
    v_cvt_pk_bf16_f32 v164, v40, v41
    v_cvt_pk_bf16_f32 v165, v42, v43
    v_cvt_pk_bf16_f32 v166, v44, v45
    v_cvt_pk_bf16_f32 v167, v46, v47
    buffer_store_dwordx4 v[164:167], v239, s[20:23], s44 offen offset:1024 sc1
    v_pk_mul_f32 v[48:49], v[48:49], v[238:239] op_sel_hi:[1,0]
    v_pk_mul_f32 v[50:51], v[50:51], v[238:239] op_sel_hi:[1,0]
    v_pk_mul_f32 v[52:53], v[52:53], v[238:239] op_sel_hi:[1,0]
    v_pk_mul_f32 v[54:55], v[54:55], v[238:239] op_sel_hi:[1,0]
    v_cvt_pk_bf16_f32 v168, v48, v49
    v_cvt_pk_bf16_f32 v169, v50, v51
    v_cvt_pk_bf16_f32 v170, v52, v53
    v_cvt_pk_bf16_f32 v171, v54, v55
    buffer_store_dwordx4 v[168:171], v239, s[20:23], s44 offen offset:2048 sc1
    v_pk_mul_f32 v[56:57], v[56:57], v[238:239] op_sel_hi:[1,0]
    v_pk_mul_f32 v[58:59], v[58:59], v[238:239] op_sel_hi:[1,0]
    v_pk_mul_f32 v[60:61], v[60:61], v[238:239] op_sel_hi:[1,0]
    v_pk_mul_f32 v[62:63], v[62:63], v[238:239] op_sel_hi:[1,0]
    v_cvt_pk_bf16_f32 v172, v56, v57
    v_cvt_pk_bf16_f32 v173, v58, v59
    v_cvt_pk_bf16_f32 v174, v60, v61
    v_cvt_pk_bf16_f32 v175, v62, v63
    buffer_store_dwordx4 v[172:175], v239, s[20:23], s44 offen offset:3072 sc1
    s_mov_b32 s70, s93
    s_add_u32 s70, s70, s79
    s_lshl_b32 s46, s70, 17
    s_lshl_b32 s47, s49, 8
    s_add_u32 s46, s46, s47
    s_add_u32 m0, s30, 131072
    s_nop 0
    buffer_load_dwordx4 v224, s[80:83], s46 offen offset:0  lds
    buffer_load_dwordx4 v225, s[80:83], s46 offen offset:1024  lds
    buffer_load_dwordx4 v226, s[80:83], s46 offen offset:2048  lds
    buffer_load_dwordx4 v227, s[80:83], s46 offen offset:3072  lds
    s_add_u32 m0, s30, 147456
    s_add_u32 s46, s46, 0x10000
    buffer_load_dwordx4 v224, s[80:83], s46 offen offset:0  lds
    buffer_load_dwordx4 v225, s[80:83], s46 offen offset:1024  lds
    buffer_load_dwordx4 v226, s[80:83], s46 offen offset:2048  lds
    buffer_load_dwordx4 v227, s[80:83], s46 offen offset:3072  lds
    s_mov_b32 s45, 32768
    s_add_u32 m0, s45, s30
    s_nop 0
    buffer_load_dwordx4 v246, s[4:7], s43 offen offset:0 nt lds
    buffer_load_dwordx4 v247, s[4:7], s43 offen offset:1024 nt lds
    buffer_load_dwordx4 v248, s[4:7], s43 offen offset:2048 nt lds
    buffer_load_dwordx4 v249, s[4:7], s43 offen offset:3072 nt lds
    s_add_u32 m0, s45, s30
    s_add_u32 m0, m0, 0x4000
    s_nop 0
    buffer_load_dwordx4 v250, s[8:11], s43 offen offset:0 nt lds
    buffer_load_dwordx4 v250, s[8:11], s43 offen offset:1024 nt lds
    buffer_load_dwordx4 v250, s[8:11], s43 offen offset:2048 nt lds
    buffer_load_dwordx4 v250, s[8:11], s43 offen offset:3072 nt lds
    s_add_u32 s43, s43, 0x4000
    s_waitcnt vmcnt(8)
    s_barrier
    s_cmp_eq_u32 s25, 0
    s_cbranch_scc0 L_nf_o1
    v_and_b32 v230, 63, v255
    v_lshlrev_b32 v230, 8, v230
    s_lshl_b32 s44, s93, 8
    s_sub_u32 s44, s3, s44
    s_lshl_b32 s45, s93, 2
    s_add_u32 s44, s44, s45
    v_mov_b32 v231, 1
    s_mov_b64 exec, 15
    buffer_store_dword v231, v230, s[20:23], s44 offen offset:0 sc1
    s_mov_b64 exec, -1
L_nf_o1:
    s_sub_u32 s47, 131072, s99
    s_mov_b32 s99, 131072
    v_add_u32 v232, s47, v232
    v_add_u32 v233, s47, v233
    v_add_u32 v234, s47, v234
    v_add_u32 v235, s47, v235
    ds_read_b64_tr_b16 v[96:97], v232 offset:0
    ds_read_b64_tr_b16 v[98:99], v232 offset:2048
    ds_read_b64_tr_b16 v[100:101], v233 offset:0
    ds_read_b64_tr_b16 v[102:103], v233 offset:2048
    ds_read_b64_tr_b16 v[104:105], v234 offset:0
    ds_read_b64_tr_b16 v[106:107], v234 offset:2048
    ds_read_b64_tr_b16 v[108:109], v235 offset:0
    ds_read_b64_tr_b16 v[110:111], v235 offset:2048
    ds_read_b64_tr_b16 v[112:113], v232 offset:4096
    ds_read_b64_tr_b16 v[114:115], v232 offset:6144
    ds_read_b64_tr_b16 v[116:117], v233 offset:4096
    ds_read_b64_tr_b16 v[118:119], v233 offset:6144
    ds_read_b64_tr_b16 v[120:121], v234 offset:4096
    ds_read_b64_tr_b16 v[122:123], v234 offset:6144
    ds_read_b64_tr_b16 v[124:125], v235 offset:4096
    ds_read_b64_tr_b16 v[126:127], v235 offset:6144
    s_waitcnt lgkmcnt(14)
    v_mfma_f32_32x32x16_bf16 v[0:15], v[96:99], v[144:147], 0
    ds_read_b64_tr_b16 v[128:129], v232 offset:8192
    ds_read_b64_tr_b16 v[130:131], v232 offset:10240
    s_waitcnt lgkmcnt(14)
    v_mfma_f32_32x32x16_bf16 v[16:31], v[100:103], v[144:147], 0
    ds_read_b64_tr_b16 v[132:133], v233 offset:8192
    ds_read_b64_tr_b16 v[134:135], v233 offset:10240
    s_waitcnt lgkmcnt(14)
    v_mfma_f32_32x32x16_bf16 v[32:47], v[104:107], v[144:147], 0
    ds_read_b64_tr_b16 v[136:137], v234 offset:8192
    ds_read_b64_tr_b16 v[138:139], v234 offset:10240
    s_waitcnt lgkmcnt(14)
    v_mfma_f32_32x32x16_bf16 v[48:63], v[108:111], v[144:147], 0
    ds_read_b64_tr_b16 v[140:141], v235 offset:8192
    ds_read_b64_tr_b16 v[142:143], v235 offset:10240
    s_waitcnt lgkmcnt(14)
    v_mfma_f32_32x32x16_bf16 v[0:15], v[112:115], v[148:151], v[0:15]
    ds_read_b64_tr_b16 v[96:97], v232 offset:12288
    ds_read_b64_tr_b16 v[98:99], v232 offset:14336
    s_waitcnt lgkmcnt(14)
    v_mfma_f32_32x32x16_bf16 v[16:31], v[116:119], v[148:151], v[16:31]
    ds_read_b64_tr_b16 v[100:101], v233 offset:12288
    ds_read_b64_tr_b16 v[102:103], v233 offset:14336
    s_waitcnt lgkmcnt(14)
    v_mfma_f32_32x32x16_bf16 v[32:47], v[120:123], v[148:151], v[32:47]
    ds_read_b64_tr_b16 v[104:105], v234 offset:12288
    ds_read_b64_tr_b16 v[106:107], v234 offset:14336
    s_waitcnt lgkmcnt(14)
    v_mfma_f32_32x32x16_bf16 v[48:63], v[124:127], v[148:151], v[48:63]
    ds_read_b64_tr_b16 v[108:109], v235 offset:12288
    ds_read_b64_tr_b16 v[110:111], v235 offset:14336
    s_waitcnt lgkmcnt(14)
    v_mfma_f32_32x32x16_bf16 v[0:15], v[128:131], v[152:155], v[0:15]
    ds_read_b64_tr_b16 v[112:113], v232 offset:16384
    ds_read_b64_tr_b16 v[114:115], v232 offset:18432
    s_waitcnt lgkmcnt(14)
    v_mfma_f32_32x32x16_bf16 v[16:31], v[132:135], v[152:155], v[16:31]
    ds_read_b64_tr_b16 v[116:117], v233 offset:16384
    ds_read_b64_tr_b16 v[118:119], v233 offset:18432
    s_waitcnt lgkmcnt(14)
    v_mfma_f32_32x32x16_bf16 v[32:47], v[136:139], v[152:155], v[32:47]
    ds_read_b64_tr_b16 v[120:121], v234 offset:16384
    ds_read_b64_tr_b16 v[122:123], v234 offset:18432
    s_waitcnt lgkmcnt(14)
    v_mfma_f32_32x32x16_bf16 v[48:63], v[140:143], v[152:155], v[48:63]
    ds_read_b64_tr_b16 v[124:125], v235 offset:16384
    ds_read_b64_tr_b16 v[126:127], v235 offset:18432
    s_waitcnt lgkmcnt(14)
    v_mfma_f32_32x32x16_bf16 v[0:15], v[96:99], v[156:159], v[0:15]
    ds_read_b64_tr_b16 v[128:129], v232 offset:20480
    ds_read_b64_tr_b16 v[130:131], v232 offset:22528
    s_waitcnt lgkmcnt(14)
    v_mfma_f32_32x32x16_bf16 v[16:31], v[100:103], v[156:159], v[16:31]
    ds_read_b64_tr_b16 v[132:133], v233 offset:20480
    ds_read_b64_tr_b16 v[134:135], v233 offset:22528
    s_waitcnt lgkmcnt(14)
    v_mfma_f32_32x32x16_bf16 v[32:47], v[104:107], v[156:159], v[32:47]
    ds_read_b64_tr_b16 v[136:137], v234 offset:20480
    ds_read_b64_tr_b16 v[138:139], v234 offset:22528
    s_waitcnt lgkmcnt(14)
    v_mfma_f32_32x32x16_bf16 v[48:63], v[108:111], v[156:159], v[48:63]
    ds_read_b64_tr_b16 v[140:141], v235 offset:20480
    ds_read_b64_tr_b16 v[142:143], v235 offset:22528
    s_waitcnt lgkmcnt(14)
    v_mfma_f32_32x32x16_bf16 v[0:15], v[112:115], v[160:163], v[0:15]
    ds_read_b64_tr_b16 v[96:97], v232 offset:24576
    ds_read_b64_tr_b16 v[98:99], v232 offset:26624
    s_waitcnt lgkmcnt(14)
    v_mfma_f32_32x32x16_bf16 v[16:31], v[116:119], v[160:163], v[16:31]
    ds_read_b64_tr_b16 v[100:101], v233 offset:24576
    ds_read_b64_tr_b16 v[102:103], v233 offset:26624
    s_waitcnt lgkmcnt(14)
    v_mfma_f32_32x32x16_bf16 v[32:47], v[120:123], v[160:163], v[32:47]
    ds_read_b64_tr_b16 v[104:105], v234 offset:24576
    ds_read_b64_tr_b16 v[106:107], v234 offset:26624
    s_waitcnt lgkmcnt(14)
    v_mfma_f32_32x32x16_bf16 v[48:63], v[124:127], v[160:163], v[48:63]
    ds_read_b64_tr_b16 v[108:109], v235 offset:24576
    ds_read_b64_tr_b16 v[110:111], v235 offset:26624
    s_waitcnt lgkmcnt(14)
    v_mfma_f32_32x32x16_bf16 v[0:15], v[128:131], v[164:167], v[0:15]
    ds_read_b64_tr_b16 v[112:113], v232 offset:28672
    ds_read_b64_tr_b16 v[114:115], v232 offset:30720
    s_waitcnt lgkmcnt(14)
    v_mfma_f32_32x32x16_bf16 v[16:31], v[132:135], v[164:167], v[16:31]
    ds_read_b64_tr_b16 v[116:117], v233 offset:28672
    ds_read_b64_tr_b16 v[118:119], v233 offset:30720
    s_waitcnt lgkmcnt(14)
    v_mfma_f32_32x32x16_bf16 v[32:47], v[136:139], v[164:167], v[32:47]
    ds_read_b64_tr_b16 v[120:121], v234 offset:28672
    ds_read_b64_tr_b16 v[122:123], v234 offset:30720
    s_waitcnt lgkmcnt(14)
    v_mfma_f32_32x32x16_bf16 v[48:63], v[140:143], v[164:167], v[48:63]
    ds_read_b64_tr_b16 v[124:125], v235 offset:28672
    ds_read_b64_tr_b16 v[126:127], v235 offset:30720
    s_waitcnt lgkmcnt(14)
    v_mfma_f32_32x32x16_bf16 v[0:15], v[96:99], v[168:171], v[0:15]
    s_waitcnt lgkmcnt(12)
    v_mfma_f32_32x32x16_bf16 v[16:31], v[100:103], v[168:171], v[16:31]
    s_waitcnt lgkmcnt(10)
    v_mfma_f32_32x32x16_bf16 v[32:47], v[104:107], v[168:171], v[32:47]
    s_waitcnt lgkmcnt(8)
    v_mfma_f32_32x32x16_bf16 v[48:63], v[108:111], v[168:171], v[48:63]
    s_waitcnt lgkmcnt(6)
    v_mfma_f32_32x32x16_bf16 v[0:15], v[112:115], v[172:175], v[0:15]
    s_waitcnt lgkmcnt(4)
    v_mfma_f32_32x32x16_bf16 v[16:31], v[116:119], v[172:175], v[16:31]
    s_waitcnt lgkmcnt(2)
    v_mfma_f32_32x32x16_bf16 v[32:47], v[120:123], v[172:175], v[32:47]
    s_waitcnt lgkmcnt(0)
    v_mfma_f32_32x32x16_bf16 v[48:63], v[124:127], v[172:175], v[48:63]
    s_lshr_b32 s70, s98, 0
    s_and_b32 s70, s70, 15
    s_add_u32 s70, s70, s93
    s_and_b32 s70, s70, 3
    s_add_u32 s70, s70, s79
    s_lshl_b32 s46, s70, 17
    s_lshl_b32 s47, s49, 8
    s_add_u32 s46, s46, s47
    s_add_u32 m0, s30, 98304
    s_nop 0
    buffer_load_dwordx4 v224, s[80:83], s46 offen offset:0  lds
    buffer_load_dwordx4 v225, s[80:83], s46 offen offset:1024  lds
    buffer_load_dwordx4 v226, s[80:83], s46 offen offset:2048  lds
    buffer_load_dwordx4 v227, s[80:83], s46 offen offset:3072  lds
    s_add_u32 m0, s30, 114688
    s_add_u32 s46, s46, 0x10000
    buffer_load_dwordx4 v224, s[80:83], s46 offen offset:0  lds
    buffer_load_dwordx4 v225, s[80:83], s46 offen offset:1024  lds
    buffer_load_dwordx4 v226, s[80:83], s46 offen offset:2048  lds
    buffer_load_dwordx4 v227, s[80:83], s46 offen offset:3072  lds
    s_mov_b32 s45, 65536
    s_add_u32 m0, s45, s30
    s_nop 0
    buffer_load_dwordx4 v246, s[4:7], s43 offen offset:0 nt lds
    buffer_load_dwordx4 v247, s[4:7], s43 offen offset:1024 nt lds
    buffer_load_dwordx4 v248, s[4:7], s43 offen offset:2048 nt lds
    buffer_load_dwordx4 v249, s[4:7], s43 offen offset:3072 nt lds
    s_add_u32 m0, s45, s30
    s_add_u32 m0, m0, 0x4000
    s_nop 0
    buffer_load_dwordx4 v250, s[8:11], s43 offen offset:0 nt lds
    buffer_load_dwordx4 v250, s[8:11], s43 offen offset:1024 nt lds
    buffer_load_dwordx4 v250, s[8:11], s43 offen offset:2048 nt lds
    buffer_load_dwordx4 v250, s[8:11], s43 offen offset:3072 nt lds
    s_add_u32 s43, s43, 0x4000
    s_waitcnt vmcnt(16)
    s_barrier
    s_lshr_b32 s70, s98, 4
    s_and_b32 s70, s70, 15
    s_add_u32 s70, s70, s93
    s_and_b32 s70, s70, 3
    s_add_u32 s70, s70, s79
    s_lshl_b32 s46, s70, 17
    s_lshl_b32 s47, s49, 8
    s_add_u32 s46, s46, s47
    s_add_u32 m0, s30, 131072
    s_nop 0
    buffer_load_dwordx4 v224, s[80:83], s46 offen offset:0  lds
    buffer_load_dwordx4 v225, s[80:83], s46 offen offset:1024  lds
    buffer_load_dwordx4 v226, s[80:83], s46 offen offset:2048  lds
    buffer_load_dwordx4 v227, s[80:83], s46 offen offset:3072  lds
    s_add_u32 m0, s30, 147456
    s_add_u32 s46, s46, 0x10000
    buffer_load_dwordx4 v224, s[80:83], s46 offen offset:0  lds
    buffer_load_dwordx4 v225, s[80:83], s46 offen offset:1024  lds
    buffer_load_dwordx4 v226, s[80:83], s46 offen offset:2048  lds
    buffer_load_dwordx4 v227, s[80:83], s46 offen offset:3072  lds
    buffer_load_dwordx4 v[208:211], off, s[20:23], s3 offset:0 sc1
    s_mov_b32 s45, 0
    s_add_u32 m0, s45, s30
    s_nop 0
    buffer_load_dwordx4 v246, s[4:7], s43 offen offset:0 nt lds
    buffer_load_dwordx4 v247, s[4:7], s43 offen offset:1024 nt lds
    buffer_load_dwordx4 v248, s[4:7], s43 offen offset:2048 nt lds
    buffer_load_dwordx4 v249, s[4:7], s43 offen offset:3072 nt lds
    s_add_u32 m0, s45, s30
    s_add_u32 m0, m0, 0x4000
    s_nop 0
    buffer_load_dwordx4 v250, s[8:11], s43 offen offset:0 nt lds
    buffer_load_dwordx4 v250, s[8:11], s43 offen offset:1024 nt lds
    buffer_load_dwordx4 v250, s[8:11], s43 offen offset:2048 nt lds
    buffer_load_dwordx4 v250, s[8:11], s43 offen offset:3072 nt lds
    s_add_u32 s43, s43, 0x4000
    s_waitcnt vmcnt(17)
    s_barrier
    s_waitcnt vmcnt(8)
    s_mov_b32 s96, 400000
    s_branch L_pc_o1
L_pl_o1:
    buffer_load_dwordx4 v[208:211], off, s[20:23], s3 offset:0 sc1
    s_waitcnt vmcnt(0)
L_pc_o1:
    v_and_b32 v208, v208, v209
    v_and_b32 v210, v210, v211
    v_and_b32 v208, v208, v210
    s_nop 0
    v_readfirstlane_b32 s44, v208
    s_cmp_eq_u32 s44, 1
    s_cbranch_scc1 L_pd_o1
    s_sub_u32 s96, s96, 1
    s_cbranch_scc0 L_pl_o1
L_pd_o1:
    s_lshr_b32 s70, s98, 0
    s_and_b32 s70, s70, 15
    s_add_u32 s70, s70, s93
    s_and_b32 s70, s70, 3
    s_add_u32 s70, s70, s79
    s_lshl_b32 s46, s70, 13
    s_add_u32 s46, s46, s97
    buffer_load_dwordx4 v[176:179], v228, s[20:23], s46 offen offset:0 sc1
    buffer_load_dwordx4 v[180:183], v228, s[20:23], s46 offen offset:1024 sc1
    buffer_load_dwordx4 v[184:187], v228, s[20:23], s46 offen offset:2048 sc1
    buffer_load_dwordx4 v[188:191], v228, s[20:23], s46 offen offset:3072 sc1
    s_add_u32 s46, s46, 4096
    buffer_load_dwordx4 v[192:195], v228, s[20:23], s46 offen offset:0 sc1
    buffer_load_dwordx4 v[196:199], v228, s[20:23], s46 offen offset:1024 sc1
    buffer_load_dwordx4 v[200:203], v228, s[20:23], s46 offen offset:2048 sc1
    buffer_load_dwordx4 v[204:207], v228, s[20:23], s46 offen offset:3072 sc1
    s_lshr_b32 s70, s98, 4
    s_and_b32 s70, s70, 15
    s_add_u32 s70, s70, s93
    s_and_b32 s70, s70, 3
    s_add_u32 s70, s70, s79
    s_lshl_b32 s46, s70, 13
    s_add_u32 s46, s46, s97
    buffer_load_dwordx4 v[64:67], v228, s[20:23], s46 offen offset:0 sc1
    buffer_load_dwordx4 v[68:71], v228, s[20:23], s46 offen offset:1024 sc1
    buffer_load_dwordx4 v[72:75], v228, s[20:23], s46 offen offset:2048 sc1
    buffer_load_dwordx4 v[76:79], v228, s[20:23], s46 offen offset:3072 sc1
    s_add_u32 s46, s46, 4096
    buffer_load_dwordx4 v[80:83], v228, s[20:23], s46 offen offset:0 sc1
    buffer_load_dwordx4 v[84:87], v228, s[20:23], s46 offen offset:1024 sc1
    buffer_load_dwordx4 v[88:91], v228, s[20:23], s46 offen offset:2048 sc1
    buffer_load_dwordx4 v[92:95], v228, s[20:23], s46 offen offset:3072 sc1
    s_mov_b32 s45, 32768
    s_add_u32 m0, s45, s30
    s_nop 0
    buffer_load_dwordx4 v246, s[4:7], s43 offen offset:0 nt lds
    buffer_load_dwordx4 v247, s[4:7], s43 offen offset:1024 nt lds
    buffer_load_dwordx4 v248, s[4:7], s43 offen offset:2048 nt lds
    buffer_load_dwordx4 v249, s[4:7], s43 offen offset:3072 nt lds
    s_add_u32 m0, s45, s30
    s_add_u32 m0, m0, 0x4000
    s_nop 0
    buffer_load_dwordx4 v250, s[8:11], s43 offen offset:0 nt lds
    buffer_load_dwordx4 v250, s[8:11], s43 offen offset:1024 nt lds
    buffer_load_dwordx4 v250, s[8:11], s43 offen offset:2048 nt lds
    buffer_load_dwordx4 v250, s[8:11], s43 offen offset:3072 nt lds
    s_add_u32 s43, s43, 0x4000
    s_waitcnt vmcnt(24)
    s_barrier
    s_waitcnt vmcnt(16)
    s_sub_u32 s47, 98304, s99
    s_mov_b32 s99, 98304
    v_add_u32 v232, s47, v232
    v_add_u32 v233, s47, v233
    v_add_u32 v234, s47, v234
    v_add_u32 v235, s47, v235
    ds_read_b64_tr_b16 v[96:97], v232 offset:0
    ds_read_b64_tr_b16 v[98:99], v232 offset:2048
    ds_read_b64_tr_b16 v[100:101], v233 offset:0
    ds_read_b64_tr_b16 v[102:103], v233 offset:2048
    ds_read_b64_tr_b16 v[104:105], v234 offset:0
    ds_read_b64_tr_b16 v[106:107], v234 offset:2048
    ds_read_b64_tr_b16 v[108:109], v235 offset:0
    ds_read_b64_tr_b16 v[110:111], v235 offset:2048
    ds_read_b64_tr_b16 v[112:113], v232 offset:4096
    ds_read_b64_tr_b16 v[114:115], v232 offset:6144
    ds_read_b64_tr_b16 v[116:117], v233 offset:4096
    ds_read_b64_tr_b16 v[118:119], v233 offset:6144
    ds_read_b64_tr_b16 v[120:121], v234 offset:4096
    ds_read_b64_tr_b16 v[122:123], v234 offset:6144
    ds_read_b64_tr_b16 v[124:125], v235 offset:4096
    ds_read_b64_tr_b16 v[126:127], v235 offset:6144
    s_waitcnt lgkmcnt(14)
    v_mfma_f32_32x32x16_bf16 v[0:15], v[96:99], v[176:179], v[0:15]
    ds_read_b64_tr_b16 v[128:129], v232 offset:8192
    ds_read_b64_tr_b16 v[130:131], v232 offset:10240
    s_waitcnt lgkmcnt(14)
    v_mfma_f32_32x32x16_bf16 v[16:31], v[100:103], v[176:179], v[16:31]
    ds_read_b64_tr_b16 v[132:133], v233 offset:8192
    ds_read_b64_tr_b16 v[134:135], v233 offset:10240
    s_waitcnt lgkmcnt(14)
    v_mfma_f32_32x32x16_bf16 v[32:47], v[104:107], v[176:179], v[32:47]
    ds_read_b64_tr_b16 v[136:137], v234 offset:8192
    ds_read_b64_tr_b16 v[138:139], v234 offset:10240
    s_waitcnt lgkmcnt(14)
    v_mfma_f32_32x32x16_bf16 v[48:63], v[108:111], v[176:179], v[48:63]
    ds_read_b64_tr_b16 v[140:141], v235 offset:8192
    ds_read_b64_tr_b16 v[142:143], v235 offset:10240
    s_waitcnt lgkmcnt(14)
    v_mfma_f32_32x32x16_bf16 v[0:15], v[112:115], v[180:183], v[0:15]
    ds_read_b64_tr_b16 v[96:97], v232 offset:12288
    ds_read_b64_tr_b16 v[98:99], v232 offset:14336
    s_waitcnt lgkmcnt(14)
    v_mfma_f32_32x32x16_bf16 v[16:31], v[116:119], v[180:183], v[16:31]
    ds_read_b64_tr_b16 v[100:101], v233 offset:12288
    ds_read_b64_tr_b16 v[102:103], v233 offset:14336
    s_waitcnt lgkmcnt(14)
    v_mfma_f32_32x32x16_bf16 v[32:47], v[120:123], v[180:183], v[32:47]
    ds_read_b64_tr_b16 v[104:105], v234 offset:12288
    ds_read_b64_tr_b16 v[106:107], v234 offset:14336
    s_waitcnt lgkmcnt(14)
    v_mfma_f32_32x32x16_bf16 v[48:63], v[124:127], v[180:183], v[48:63]
    ds_read_b64_tr_b16 v[108:109], v235 offset:12288
    ds_read_b64_tr_b16 v[110:111], v235 offset:14336
    s_waitcnt lgkmcnt(14)
    v_mfma_f32_32x32x16_bf16 v[0:15], v[128:131], v[184:187], v[0:15]
    ds_read_b64_tr_b16 v[112:113], v232 offset:16384
    ds_read_b64_tr_b16 v[114:115], v232 offset:18432
    s_waitcnt lgkmcnt(14)
    v_mfma_f32_32x32x16_bf16 v[16:31], v[132:135], v[184:187], v[16:31]
    ds_read_b64_tr_b16 v[116:117], v233 offset:16384
    ds_read_b64_tr_b16 v[118:119], v233 offset:18432
    s_waitcnt lgkmcnt(14)
    v_mfma_f32_32x32x16_bf16 v[32:47], v[136:139], v[184:187], v[32:47]
    ds_read_b64_tr_b16 v[120:121], v234 offset:16384
    ds_read_b64_tr_b16 v[122:123], v234 offset:18432
    s_waitcnt lgkmcnt(14)
    v_mfma_f32_32x32x16_bf16 v[48:63], v[140:143], v[184:187], v[48:63]
    ds_read_b64_tr_b16 v[124:125], v235 offset:16384
    ds_read_b64_tr_b16 v[126:127], v235 offset:18432
    s_waitcnt lgkmcnt(14)
    v_mfma_f32_32x32x16_bf16 v[0:15], v[96:99], v[188:191], v[0:15]
    ds_read_b64_tr_b16 v[128:129], v232 offset:20480
    ds_read_b64_tr_b16 v[130:131], v232 offset:22528
    s_waitcnt lgkmcnt(14)
    v_mfma_f32_32x32x16_bf16 v[16:31], v[100:103], v[188:191], v[16:31]
    ds_read_b64_tr_b16 v[132:133], v233 offset:20480
    ds_read_b64_tr_b16 v[134:135], v233 offset:22528
    s_waitcnt lgkmcnt(14)
    v_mfma_f32_32x32x16_bf16 v[32:47], v[104:107], v[188:191], v[32:47]
    ds_read_b64_tr_b16 v[136:137], v234 offset:20480
    ds_read_b64_tr_b16 v[138:139], v234 offset:22528
    s_waitcnt lgkmcnt(14)
    v_mfma_f32_32x32x16_bf16 v[48:63], v[108:111], v[188:191], v[48:63]
    ds_read_b64_tr_b16 v[140:141], v235 offset:20480
    ds_read_b64_tr_b16 v[142:143], v235 offset:22528
    s_waitcnt lgkmcnt(14)
    v_mfma_f32_32x32x16_bf16 v[0:15], v[112:115], v[192:195], v[0:15]
    ds_read_b64_tr_b16 v[96:97], v232 offset:24576
    ds_read_b64_tr_b16 v[98:99], v232 offset:26624
    s_waitcnt lgkmcnt(14)
    v_mfma_f32_32x32x16_bf16 v[16:31], v[116:119], v[192:195], v[16:31]
    ds_read_b64_tr_b16 v[100:101], v233 offset:24576
    ds_read_b64_tr_b16 v[102:103], v233 offset:26624
    s_waitcnt lgkmcnt(14)
    v_mfma_f32_32x32x16_bf16 v[32:47], v[120:123], v[192:195], v[32:47]
    ds_read_b64_tr_b16 v[104:105], v234 offset:24576
    ds_read_b64_tr_b16 v[106:107], v234 offset:26624
    s_waitcnt lgkmcnt(14)
    v_mfma_f32_32x32x16_bf16 v[48:63], v[124:127], v[192:195], v[48:63]
    ds_read_b64_tr_b16 v[108:109], v235 offset:24576
    ds_read_b64_tr_b16 v[110:111], v235 offset:26624
    s_waitcnt lgkmcnt(14)
    v_mfma_f32_32x32x16_bf16 v[0:15], v[128:131], v[196:199], v[0:15]
    ds_read_b64_tr_b16 v[112:113], v232 offset:28672
    ds_read_b64_tr_b16 v[114:115], v232 offset:30720
    s_waitcnt lgkmcnt(14)
    v_mfma_f32_32x32x16_bf16 v[16:31], v[132:135], v[196:199], v[16:31]
    ds_read_b64_tr_b16 v[116:117], v233 offset:28672
    ds_read_b64_tr_b16 v[118:119], v233 offset:30720
    s_waitcnt lgkmcnt(14)
    v_mfma_f32_32x32x16_bf16 v[32:47], v[136:139], v[196:199], v[32:47]
    ds_read_b64_tr_b16 v[120:121], v234 offset:28672
    ds_read_b64_tr_b16 v[122:123], v234 offset:30720
    s_waitcnt lgkmcnt(14)
    v_mfma_f32_32x32x16_bf16 v[48:63], v[140:143], v[196:199], v[48:63]
    ds_read_b64_tr_b16 v[124:125], v235 offset:28672
    ds_read_b64_tr_b16 v[126:127], v235 offset:30720
    s_waitcnt lgkmcnt(14)
    v_mfma_f32_32x32x16_bf16 v[0:15], v[96:99], v[200:203], v[0:15]
    s_waitcnt lgkmcnt(12)
    v_mfma_f32_32x32x16_bf16 v[16:31], v[100:103], v[200:203], v[16:31]
    s_waitcnt lgkmcnt(10)
    v_mfma_f32_32x32x16_bf16 v[32:47], v[104:107], v[200:203], v[32:47]
    s_waitcnt lgkmcnt(8)
    v_mfma_f32_32x32x16_bf16 v[48:63], v[108:111], v[200:203], v[48:63]
    s_waitcnt lgkmcnt(6)
    v_mfma_f32_32x32x16_bf16 v[0:15], v[112:115], v[204:207], v[0:15]
    s_waitcnt lgkmcnt(4)
    v_mfma_f32_32x32x16_bf16 v[16:31], v[116:119], v[204:207], v[16:31]
    s_waitcnt lgkmcnt(2)
    v_mfma_f32_32x32x16_bf16 v[32:47], v[120:123], v[204:207], v[32:47]
    s_waitcnt lgkmcnt(0)
    v_mfma_f32_32x32x16_bf16 v[48:63], v[124:127], v[204:207], v[48:63]
    s_lshr_b32 s70, s98, 8
    s_and_b32 s70, s70, 15
    s_add_u32 s70, s70, s93
    s_and_b32 s70, s70, 3
    s_add_u32 s70, s70, s79
    s_lshl_b32 s46, s70, 13
    s_add_u32 s46, s46, s97
    buffer_load_dwordx4 v[144:147], v228, s[20:23], s46 offen offset:0 sc1
    buffer_load_dwordx4 v[148:151], v228, s[20:23], s46 offen offset:1024 sc1
    buffer_load_dwordx4 v[152:155], v228, s[20:23], s46 offen offset:2048 sc1
    buffer_load_dwordx4 v[156:159], v228, s[20:23], s46 offen offset:3072 sc1
    s_add_u32 s46, s46, 4096
    buffer_load_dwordx4 v[160:163], v228, s[20:23], s46 offen offset:0 sc1
    buffer_load_dwordx4 v[164:167], v228, s[20:23], s46 offen offset:1024 sc1
    buffer_load_dwordx4 v[168:171], v228, s[20:23], s46 offen offset:2048 sc1
    buffer_load_dwordx4 v[172:175], v228, s[20:23], s46 offen offset:3072 sc1
    s_mov_b32 s45, 65536
    s_add_u32 m0, s45, s30
    s_nop 0
    buffer_load_dwordx4 v246, s[4:7], s43 offen offset:0 nt lds
    buffer_load_dwordx4 v247, s[4:7], s43 offen offset:1024 nt lds
    buffer_load_dwordx4 v248, s[4:7], s43 offen offset:2048 nt lds
    buffer_load_dwordx4 v249, s[4:7], s43 offen offset:3072 nt lds
    s_add_u32 m0, s45, s30
    s_add_u32 m0, m0, 0x4000
    s_nop 0
    buffer_load_dwordx4 v250, s[8:11], s43 offen offset:0 nt lds
    buffer_load_dwordx4 v250, s[8:11], s43 offen offset:1024 nt lds
    buffer_load_dwordx4 v250, s[8:11], s43 offen offset:2048 nt lds
    buffer_load_dwordx4 v250, s[8:11], s43 offen offset:3072 nt lds
    s_add_u32 s43, s43, 0x4000
    s_waitcnt vmcnt(16)
    s_barrier
    s_sub_u32 s47, 131072, s99
    s_mov_b32 s99, 131072
    v_add_u32 v232, s47, v232
    v_add_u32 v233, s47, v233
    v_add_u32 v234, s47, v234
    v_add_u32 v235, s47, v235
    ds_read_b64_tr_b16 v[96:97], v232 offset:0
    ds_read_b64_tr_b16 v[98:99], v232 offset:2048
    ds_read_b64_tr_b16 v[100:101], v233 offset:0
    ds_read_b64_tr_b16 v[102:103], v233 offset:2048
    ds_read_b64_tr_b16 v[104:105], v234 offset:0
    ds_read_b64_tr_b16 v[106:107], v234 offset:2048
    ds_read_b64_tr_b16 v[108:109], v235 offset:0
    ds_read_b64_tr_b16 v[110:111], v235 offset:2048
    ds_read_b64_tr_b16 v[112:113], v232 offset:4096
    ds_read_b64_tr_b16 v[114:115], v232 offset:6144
    ds_read_b64_tr_b16 v[116:117], v233 offset:4096
    ds_read_b64_tr_b16 v[118:119], v233 offset:6144
    ds_read_b64_tr_b16 v[120:121], v234 offset:4096
    ds_read_b64_tr_b16 v[122:123], v234 offset:6144
    ds_read_b64_tr_b16 v[124:125], v235 offset:4096
    ds_read_b64_tr_b16 v[126:127], v235 offset:6144
    s_waitcnt lgkmcnt(14)
    v_mfma_f32_32x32x16_bf16 v[0:15], v[96:99], v[64:67], v[0:15]
    ds_read_b64_tr_b16 v[128:129], v232 offset:8192
    ds_read_b64_tr_b16 v[130:131], v232 offset:10240
    s_waitcnt lgkmcnt(14)
    v_mfma_f32_32x32x16_bf16 v[16:31], v[100:103], v[64:67], v[16:31]
    ds_read_b64_tr_b16 v[132:133], v233 offset:8192
    ds_read_b64_tr_b16 v[134:135], v233 offset:10240
    s_waitcnt lgkmcnt(14)
    v_mfma_f32_32x32x16_bf16 v[32:47], v[104:107], v[64:67], v[32:47]
    ds_read_b64_tr_b16 v[136:137], v234 offset:8192
    ds_read_b64_tr_b16 v[138:139], v234 offset:10240
    s_waitcnt lgkmcnt(14)
    v_mfma_f32_32x32x16_bf16 v[48:63], v[108:111], v[64:67], v[48:63]
    ds_read_b64_tr_b16 v[140:141], v235 offset:8192
    ds_read_b64_tr_b16 v[142:143], v235 offset:10240
    s_waitcnt lgkmcnt(14)
    v_mfma_f32_32x32x16_bf16 v[0:15], v[112:115], v[68:71], v[0:15]
    ds_read_b64_tr_b16 v[96:97], v232 offset:12288
    ds_read_b64_tr_b16 v[98:99], v232 offset:14336
    s_waitcnt lgkmcnt(14)
    v_mfma_f32_32x32x16_bf16 v[16:31], v[116:119], v[68:71], v[16:31]
    ds_read_b64_tr_b16 v[100:101], v233 offset:12288
    ds_read_b64_tr_b16 v[102:103], v233 offset:14336
    s_waitcnt lgkmcnt(14)
    v_mfma_f32_32x32x16_bf16 v[32:47], v[120:123], v[68:71], v[32:47]
    ds_read_b64_tr_b16 v[104:105], v234 offset:12288
    ds_read_b64_tr_b16 v[106:107], v234 offset:14336
    s_waitcnt lgkmcnt(14)
    v_mfma_f32_32x32x16_bf16 v[48:63], v[124:127], v[68:71], v[48:63]
    ds_read_b64_tr_b16 v[108:109], v235 offset:12288
    ds_read_b64_tr_b16 v[110:111], v235 offset:14336
    s_waitcnt lgkmcnt(14)
    v_mfma_f32_32x32x16_bf16 v[0:15], v[128:131], v[72:75], v[0:15]
    ds_read_b64_tr_b16 v[112:113], v232 offset:16384
    ds_read_b64_tr_b16 v[114:115], v232 offset:18432
    s_waitcnt lgkmcnt(14)
    v_mfma_f32_32x32x16_bf16 v[16:31], v[132:135], v[72:75], v[16:31]
    ds_read_b64_tr_b16 v[116:117], v233 offset:16384
    ds_read_b64_tr_b16 v[118:119], v233 offset:18432
    s_waitcnt lgkmcnt(14)
    v_mfma_f32_32x32x16_bf16 v[32:47], v[136:139], v[72:75], v[32:47]
    ds_read_b64_tr_b16 v[120:121], v234 offset:16384
    ds_read_b64_tr_b16 v[122:123], v234 offset:18432
    s_waitcnt lgkmcnt(14)
    v_mfma_f32_32x32x16_bf16 v[48:63], v[140:143], v[72:75], v[48:63]
    ds_read_b64_tr_b16 v[124:125], v235 offset:16384
    ds_read_b64_tr_b16 v[126:127], v235 offset:18432
    s_waitcnt lgkmcnt(14)
    v_mfma_f32_32x32x16_bf16 v[0:15], v[96:99], v[76:79], v[0:15]
    ds_read_b64_tr_b16 v[128:129], v232 offset:20480
    ds_read_b64_tr_b16 v[130:131], v232 offset:22528
    s_waitcnt lgkmcnt(14)
    v_mfma_f32_32x32x16_bf16 v[16:31], v[100:103], v[76:79], v[16:31]
    ds_read_b64_tr_b16 v[132:133], v233 offset:20480
    ds_read_b64_tr_b16 v[134:135], v233 offset:22528
    s_waitcnt lgkmcnt(14)
    v_mfma_f32_32x32x16_bf16 v[32:47], v[104:107], v[76:79], v[32:47]
    ds_read_b64_tr_b16 v[136:137], v234 offset:20480
    ds_read_b64_tr_b16 v[138:139], v234 offset:22528
    s_waitcnt lgkmcnt(14)
    v_mfma_f32_32x32x16_bf16 v[48:63], v[108:111], v[76:79], v[48:63]
    ds_read_b64_tr_b16 v[140:141], v235 offset:20480
    ds_read_b64_tr_b16 v[142:143], v235 offset:22528
    s_waitcnt lgkmcnt(14)
    v_mfma_f32_32x32x16_bf16 v[0:15], v[112:115], v[80:83], v[0:15]
    ds_read_b64_tr_b16 v[96:97], v232 offset:24576
    ds_read_b64_tr_b16 v[98:99], v232 offset:26624
    s_waitcnt lgkmcnt(14)
    v_mfma_f32_32x32x16_bf16 v[16:31], v[116:119], v[80:83], v[16:31]
    ds_read_b64_tr_b16 v[100:101], v233 offset:24576
    ds_read_b64_tr_b16 v[102:103], v233 offset:26624
    s_waitcnt lgkmcnt(14)
    v_mfma_f32_32x32x16_bf16 v[32:47], v[120:123], v[80:83], v[32:47]
    ds_read_b64_tr_b16 v[104:105], v234 offset:24576
    ds_read_b64_tr_b16 v[106:107], v234 offset:26624
    s_waitcnt lgkmcnt(14)
    v_mfma_f32_32x32x16_bf16 v[48:63], v[124:127], v[80:83], v[48:63]
    ds_read_b64_tr_b16 v[108:109], v235 offset:24576
    ds_read_b64_tr_b16 v[110:111], v235 offset:26624
    s_waitcnt lgkmcnt(14)
    v_mfma_f32_32x32x16_bf16 v[0:15], v[128:131], v[84:87], v[0:15]
    ds_read_b64_tr_b16 v[112:113], v232 offset:28672
    ds_read_b64_tr_b16 v[114:115], v232 offset:30720
    s_waitcnt lgkmcnt(14)
    v_mfma_f32_32x32x16_bf16 v[16:31], v[132:135], v[84:87], v[16:31]
    ds_read_b64_tr_b16 v[116:117], v233 offset:28672
    ds_read_b64_tr_b16 v[118:119], v233 offset:30720
    s_waitcnt lgkmcnt(14)
    v_mfma_f32_32x32x16_bf16 v[32:47], v[136:139], v[84:87], v[32:47]
    ds_read_b64_tr_b16 v[120:121], v234 offset:28672
    ds_read_b64_tr_b16 v[122:123], v234 offset:30720
    s_waitcnt lgkmcnt(14)
    v_mfma_f32_32x32x16_bf16 v[48:63], v[140:143], v[84:87], v[48:63]
    ds_read_b64_tr_b16 v[124:125], v235 offset:28672
    ds_read_b64_tr_b16 v[126:127], v235 offset:30720
    s_waitcnt lgkmcnt(14)
    v_mfma_f32_32x32x16_bf16 v[0:15], v[96:99], v[88:91], v[0:15]
    s_waitcnt lgkmcnt(12)
    v_mfma_f32_32x32x16_bf16 v[16:31], v[100:103], v[88:91], v[16:31]
    s_waitcnt lgkmcnt(10)
    v_mfma_f32_32x32x16_bf16 v[32:47], v[104:107], v[88:91], v[32:47]
    s_waitcnt lgkmcnt(8)
    v_mfma_f32_32x32x16_bf16 v[48:63], v[108:111], v[88:91], v[48:63]
    s_waitcnt lgkmcnt(6)
    v_mfma_f32_32x32x16_bf16 v[0:15], v[112:115], v[92:95], v[0:15]
    s_waitcnt lgkmcnt(4)
    v_mfma_f32_32x32x16_bf16 v[16:31], v[116:119], v[92:95], v[16:31]
    s_waitcnt lgkmcnt(2)
    v_mfma_f32_32x32x16_bf16 v[32:47], v[120:123], v[92:95], v[32:47]
    s_waitcnt lgkmcnt(0)
    v_mfma_f32_32x32x16_bf16 v[48:63], v[124:127], v[92:95], v[48:63]
    s_lshr_b32 s70, s98, 8
    s_and_b32 s70, s70, 15
    s_add_u32 s70, s70, s93
    s_and_b32 s70, s70, 3
    s_add_u32 s70, s70, s79
    s_lshl_b32 s46, s70, 17
    s_lshl_b32 s47, s49, 8
    s_add_u32 s46, s46, s47
    s_add_u32 m0, s30, 98304
    s_nop 0
    buffer_load_dwordx4 v224, s[80:83], s46 offen offset:0  lds
    buffer_load_dwordx4 v225, s[80:83], s46 offen offset:1024  lds
    buffer_load_dwordx4 v226, s[80:83], s46 offen offset:2048  lds
    buffer_load_dwordx4 v227, s[80:83], s46 offen offset:3072  lds
    s_add_u32 m0, s30, 114688
    s_add_u32 s46, s46, 0x10000
    buffer_load_dwordx4 v224, s[80:83], s46 offen offset:0  lds
    buffer_load_dwordx4 v225, s[80:83], s46 offen offset:1024  lds
    buffer_load_dwordx4 v226, s[80:83], s46 offen offset:2048  lds
    buffer_load_dwordx4 v227, s[80:83], s46 offen offset:3072  lds
    s_mov_b32 s45, 0
    s_add_u32 m0, s45, s30
    s_nop 0
    buffer_load_dwordx4 v246, s[4:7], s43 offen offset:0 nt lds
    buffer_load_dwordx4 v247, s[4:7], s43 offen offset:1024 nt lds
    buffer_load_dwordx4 v248, s[4:7], s43 offen offset:2048 nt lds
    buffer_load_dwordx4 v249, s[4:7], s43 offen offset:3072 nt lds
    s_add_u32 m0, s45, s30
    s_add_u32 m0, m0, 0x4000
    s_nop 0
    buffer_load_dwordx4 v250, s[8:11], s43 offen offset:0 nt lds
    buffer_load_dwordx4 v250, s[8:11], s43 offen offset:1024 nt lds
    buffer_load_dwordx4 v250, s[8:11], s43 offen offset:2048 nt lds
    buffer_load_dwordx4 v250, s[8:11], s43 offen offset:3072 nt lds
    s_add_u32 s43, s43, 0x4000
    s_waitcnt vmcnt(8)
    s_barrier
    s_sub_u32 s47, 98304, s99
    s_mov_b32 s99, 98304
    v_add_u32 v232, s47, v232
    v_add_u32 v233, s47, v233
    v_add_u32 v234, s47, v234
    v_add_u32 v235, s47, v235
    ds_read_b64_tr_b16 v[96:97], v232 offset:0
    ds_read_b64_tr_b16 v[98:99], v232 offset:2048
    ds_read_b64_tr_b16 v[100:101], v233 offset:0
    ds_read_b64_tr_b16 v[102:103], v233 offset:2048
    ds_read_b64_tr_b16 v[104:105], v234 offset:0
    ds_read_b64_tr_b16 v[106:107], v234 offset:2048
    ds_read_b64_tr_b16 v[108:109], v235 offset:0
    ds_read_b64_tr_b16 v[110:111], v235 offset:2048
    ds_read_b64_tr_b16 v[112:113], v232 offset:4096
    ds_read_b64_tr_b16 v[114:115], v232 offset:6144
    ds_read_b64_tr_b16 v[116:117], v233 offset:4096
    ds_read_b64_tr_b16 v[118:119], v233 offset:6144
    ds_read_b64_tr_b16 v[120:121], v234 offset:4096
    ds_read_b64_tr_b16 v[122:123], v234 offset:6144
    ds_read_b64_tr_b16 v[124:125], v235 offset:4096
    ds_read_b64_tr_b16 v[126:127], v235 offset:6144
    s_waitcnt lgkmcnt(14)
    v_mfma_f32_32x32x16_bf16 v[0:15], v[96:99], v[144:147], v[0:15]
    ds_read_b64_tr_b16 v[128:129], v232 offset:8192
    ds_read_b64_tr_b16 v[130:131], v232 offset:10240
    s_waitcnt lgkmcnt(14)
    v_mfma_f32_32x32x16_bf16 v[16:31], v[100:103], v[144:147], v[16:31]
    ds_read_b64_tr_b16 v[132:133], v233 offset:8192
    ds_read_b64_tr_b16 v[134:135], v233 offset:10240
    s_waitcnt lgkmcnt(14)
    v_mfma_f32_32x32x16_bf16 v[32:47], v[104:107], v[144:147], v[32:47]
    ds_read_b64_tr_b16 v[136:137], v234 offset:8192
    ds_read_b64_tr_b16 v[138:139], v234 offset:10240
    s_waitcnt lgkmcnt(14)
    v_mfma_f32_32x32x16_bf16 v[48:63], v[108:111], v[144:147], v[48:63]
    ds_read_b64_tr_b16 v[140:141], v235 offset:8192
    ds_read_b64_tr_b16 v[142:143], v235 offset:10240
    s_waitcnt lgkmcnt(14)
    v_mfma_f32_32x32x16_bf16 v[0:15], v[112:115], v[148:151], v[0:15]
    ds_read_b64_tr_b16 v[96:97], v232 offset:12288
    ds_read_b64_tr_b16 v[98:99], v232 offset:14336
    s_waitcnt lgkmcnt(14)
    v_mfma_f32_32x32x16_bf16 v[16:31], v[116:119], v[148:151], v[16:31]
    ds_read_b64_tr_b16 v[100:101], v233 offset:12288
    ds_read_b64_tr_b16 v[102:103], v233 offset:14336
    s_waitcnt lgkmcnt(14)
    v_mfma_f32_32x32x16_bf16 v[32:47], v[120:123], v[148:151], v[32:47]
    ds_read_b64_tr_b16 v[104:105], v234 offset:12288
    ds_read_b64_tr_b16 v[106:107], v234 offset:14336
    s_waitcnt lgkmcnt(14)
    v_mfma_f32_32x32x16_bf16 v[48:63], v[124:127], v[148:151], v[48:63]
    ds_read_b64_tr_b16 v[108:109], v235 offset:12288
    ds_read_b64_tr_b16 v[110:111], v235 offset:14336
    s_waitcnt lgkmcnt(14)
    v_mfma_f32_32x32x16_bf16 v[0:15], v[128:131], v[152:155], v[0:15]
    ds_read_b64_tr_b16 v[112:113], v232 offset:16384
    ds_read_b64_tr_b16 v[114:115], v232 offset:18432
    s_waitcnt lgkmcnt(14)
    v_mfma_f32_32x32x16_bf16 v[16:31], v[132:135], v[152:155], v[16:31]
    ds_read_b64_tr_b16 v[116:117], v233 offset:16384
    ds_read_b64_tr_b16 v[118:119], v233 offset:18432
    s_waitcnt lgkmcnt(14)
    v_mfma_f32_32x32x16_bf16 v[32:47], v[136:139], v[152:155], v[32:47]
    ds_read_b64_tr_b16 v[120:121], v234 offset:16384
    ds_read_b64_tr_b16 v[122:123], v234 offset:18432
    s_waitcnt lgkmcnt(14)
    v_mfma_f32_32x32x16_bf16 v[48:63], v[140:143], v[152:155], v[48:63]
    ds_read_b64_tr_b16 v[124:125], v235 offset:16384
    ds_read_b64_tr_b16 v[126:127], v235 offset:18432
    s_waitcnt lgkmcnt(14)
    v_mfma_f32_32x32x16_bf16 v[0:15], v[96:99], v[156:159], v[0:15]
    ds_read_b64_tr_b16 v[128:129], v232 offset:20480
    ds_read_b64_tr_b16 v[130:131], v232 offset:22528
    s_waitcnt lgkmcnt(14)
    v_mfma_f32_32x32x16_bf16 v[16:31], v[100:103], v[156:159], v[16:31]
    ds_read_b64_tr_b16 v[132:133], v233 offset:20480
    ds_read_b64_tr_b16 v[134:135], v233 offset:22528
    s_waitcnt lgkmcnt(14)
    v_mfma_f32_32x32x16_bf16 v[32:47], v[104:107], v[156:159], v[32:47]
    ds_read_b64_tr_b16 v[136:137], v234 offset:20480
    ds_read_b64_tr_b16 v[138:139], v234 offset:22528
    s_waitcnt lgkmcnt(14)
    v_mfma_f32_32x32x16_bf16 v[48:63], v[108:111], v[156:159], v[48:63]
    ds_read_b64_tr_b16 v[140:141], v235 offset:20480
    ds_read_b64_tr_b16 v[142:143], v235 offset:22528
    s_waitcnt lgkmcnt(14)
    v_mfma_f32_32x32x16_bf16 v[0:15], v[112:115], v[160:163], v[0:15]
    ds_read_b64_tr_b16 v[96:97], v232 offset:24576
    ds_read_b64_tr_b16 v[98:99], v232 offset:26624
    s_waitcnt lgkmcnt(14)
    v_mfma_f32_32x32x16_bf16 v[16:31], v[116:119], v[160:163], v[16:31]
    ds_read_b64_tr_b16 v[100:101], v233 offset:24576
    ds_read_b64_tr_b16 v[102:103], v233 offset:26624
    s_waitcnt lgkmcnt(14)
    v_mfma_f32_32x32x16_bf16 v[32:47], v[120:123], v[160:163], v[32:47]
    ds_read_b64_tr_b16 v[104:105], v234 offset:24576
    ds_read_b64_tr_b16 v[106:107], v234 offset:26624
    s_waitcnt lgkmcnt(14)
    v_mfma_f32_32x32x16_bf16 v[48:63], v[124:127], v[160:163], v[48:63]
    ds_read_b64_tr_b16 v[108:109], v235 offset:24576
    ds_read_b64_tr_b16 v[110:111], v235 offset:26624
    s_waitcnt lgkmcnt(14)
    v_mfma_f32_32x32x16_bf16 v[0:15], v[128:131], v[164:167], v[0:15]
    ds_read_b64_tr_b16 v[112:113], v232 offset:28672
    ds_read_b64_tr_b16 v[114:115], v232 offset:30720
    s_waitcnt lgkmcnt(14)
    v_mfma_f32_32x32x16_bf16 v[16:31], v[132:135], v[164:167], v[16:31]
    ds_read_b64_tr_b16 v[116:117], v233 offset:28672
    ds_read_b64_tr_b16 v[118:119], v233 offset:30720
    s_waitcnt lgkmcnt(14)
    v_mfma_f32_32x32x16_bf16 v[32:47], v[136:139], v[164:167], v[32:47]
    ds_read_b64_tr_b16 v[120:121], v234 offset:28672
    ds_read_b64_tr_b16 v[122:123], v234 offset:30720
    s_waitcnt lgkmcnt(14)
    v_mfma_f32_32x32x16_bf16 v[48:63], v[140:143], v[164:167], v[48:63]
    ds_read_b64_tr_b16 v[124:125], v235 offset:28672
    ds_read_b64_tr_b16 v[126:127], v235 offset:30720
    s_waitcnt lgkmcnt(14)
    v_mfma_f32_32x32x16_bf16 v[0:15], v[96:99], v[168:171], v[0:15]
    s_waitcnt lgkmcnt(12)
    v_mfma_f32_32x32x16_bf16 v[16:31], v[100:103], v[168:171], v[16:31]
    s_waitcnt lgkmcnt(10)
    v_mfma_f32_32x32x16_bf16 v[32:47], v[104:107], v[168:171], v[32:47]
    s_waitcnt lgkmcnt(8)
    v_mfma_f32_32x32x16_bf16 v[48:63], v[108:111], v[168:171], v[48:63]
    s_waitcnt lgkmcnt(6)
    v_mfma_f32_32x32x16_bf16 v[0:15], v[112:115], v[172:175], v[0:15]
    s_waitcnt lgkmcnt(4)
    v_mfma_f32_32x32x16_bf16 v[16:31], v[116:119], v[172:175], v[16:31]
    s_waitcnt lgkmcnt(2)
    v_mfma_f32_32x32x16_bf16 v[32:47], v[120:123], v[172:175], v[32:47]
    s_waitcnt lgkmcnt(0)
    v_mfma_f32_32x32x16_bf16 v[48:63], v[124:127], v[172:175], v[48:63]
    s_add_u32 s70, s27, 0
    s_and_b32 s70, s70, 3
    s_add_u32 s70, s70, s79
    s_add_u32 s70, s70, 16
    s_lshl_b32 s46, s70, 17
    s_lshl_b32 s47, s49, 8
    s_add_u32 s46, s46, s47
    s_add_u32 m0, s30, 131072
    s_nop 0
    buffer_load_dwordx4 v224, s[80:83], s46 offen offset:0  lds
    buffer_load_dwordx4 v225, s[80:83], s46 offen offset:1024  lds
    buffer_load_dwordx4 v226, s[80:83], s46 offen offset:2048  lds
    buffer_load_dwordx4 v227, s[80:83], s46 offen offset:3072  lds
    s_add_u32 m0, s30, 147456
    s_add_u32 s46, s46, 0x10000
    buffer_load_dwordx4 v224, s[80:83], s46 offen offset:0  lds
    buffer_load_dwordx4 v225, s[80:83], s46 offen offset:1024  lds
    buffer_load_dwordx4 v226, s[80:83], s46 offen offset:2048  lds
    buffer_load_dwordx4 v227, s[80:83], s46 offen offset:3072  lds
    s_add_u32 s70, s27, 1
    s_and_b32 s70, s70, 3
    s_add_u32 s70, s70, s79
    s_add_u32 s70, s70, 16
    s_lshl_b32 s46, s70, 17
    s_lshl_b32 s47, s49, 8
    s_add_u32 s46, s46, s47
    s_add_u32 m0, s30, 32768
    s_nop 0
    buffer_load_dwordx4 v224, s[80:83], s46 offen offset:0  lds
    buffer_load_dwordx4 v225, s[80:83], s46 offen offset:1024  lds
    buffer_load_dwordx4 v226, s[80:83], s46 offen offset:2048  lds
    buffer_load_dwordx4 v227, s[80:83], s46 offen offset:3072  lds
    s_add_u32 m0, s30, 49152
    s_add_u32 s46, s46, 0x10000
    buffer_load_dwordx4 v224, s[80:83], s46 offen offset:0  lds
    buffer_load_dwordx4 v225, s[80:83], s46 offen offset:1024  lds
    buffer_load_dwordx4 v226, s[80:83], s46 offen offset:2048  lds
    buffer_load_dwordx4 v227, s[80:83], s46 offen offset:3072  lds
    s_waitcnt vmcnt(16)
    s_barrier
    s_add_u32 s70, s27, 2
    s_and_b32 s70, s70, 3
    s_add_u32 s70, s70, s79
    s_add_u32 s70, s70, 16
    s_lshl_b32 s46, s70, 17
    s_lshl_b32 s47, s49, 8
    s_add_u32 s46, s46, s47
    s_add_u32 m0, s30, 98304
    s_nop 0
    buffer_load_dwordx4 v224, s[80:83], s46 offen offset:0  lds
    buffer_load_dwordx4 v225, s[80:83], s46 offen offset:1024  lds
    buffer_load_dwordx4 v226, s[80:83], s46 offen offset:2048  lds
    buffer_load_dwordx4 v227, s[80:83], s46 offen offset:3072  lds
    s_add_u32 m0, s30, 114688
    s_add_u32 s46, s46, 0x10000
    buffer_load_dwordx4 v224, s[80:83], s46 offen offset:0  lds
    buffer_load_dwordx4 v225, s[80:83], s46 offen offset:1024  lds
    buffer_load_dwordx4 v226, s[80:83], s46 offen offset:2048  lds
    buffer_load_dwordx4 v227, s[80:83], s46 offen offset:3072  lds
    s_add_u32 s70, s27, 3
    s_and_b32 s70, s70, 3
    s_add_u32 s70, s70, s79
    s_add_u32 s70, s70, 16
    s_lshl_b32 s46, s70, 17
    s_lshl_b32 s47, s49, 8
    s_add_u32 s46, s46, s47
    s_add_u32 m0, s30, 65536
    s_nop 0
    buffer_load_dwordx4 v224, s[80:83], s46 offen offset:0  lds
    buffer_load_dwordx4 v225, s[80:83], s46 offen offset:1024  lds
    buffer_load_dwordx4 v226, s[80:83], s46 offen offset:2048  lds
    buffer_load_dwordx4 v227, s[80:83], s46 offen offset:3072  lds
    s_add_u32 m0, s30, 81920
    s_add_u32 s46, s46, 0x10000
    buffer_load_dwordx4 v224, s[80:83], s46 offen offset:0  lds
    buffer_load_dwordx4 v225, s[80:83], s46 offen offset:1024  lds
    buffer_load_dwordx4 v226, s[80:83], s46 offen offset:2048  lds
    buffer_load_dwordx4 v227, s[80:83], s46 offen offset:3072  lds
    s_barrier
    s_lshl_b32 s59, s25, 4
    s_add_u32 s59, s59, s3
    s_lshl_b32 s53, 1, s93
    s_xor_b32 s53, s53, 15
    buffer_load_dwordx4 v[208:211], off, s[20:23], s59 offset:64 sc1
    s_waitcnt vmcnt(0)
    s_barrier
    s_lshl_b32 s44, s25, 13
    v_add_u32 v238, s44, v228
    ds_read_b128 v[144:147], v238 offset:0
    ds_read_b128 v[148:151], v238 offset:1024
    ds_read_b128 v[152:155], v238 offset:2048
    ds_read_b128 v[156:159], v238 offset:3072
    ds_read_b128 v[160:163], v238 offset:4096
    ds_read_b128 v[164:167], v238 offset:5120
    ds_read_b128 v[168:171], v238 offset:6144
    ds_read_b128 v[172:175], v238 offset:7168
    s_sub_u32 s47, s48, s27
    s_and_b32 s47, s47, 3
    s_lshl_b32 s47, s47, 2
    s_lshr_b32 s47, 8980, s47
    s_and_b32 s47, s47, 7
    s_lshl_b32 s46, s47, 15
    s_sub_u32 s47, s46, s99
    s_mov_b32 s99, s46
    v_add_u32 v232, s47, v232
    v_add_u32 v233, s47, v233
    v_add_u32 v234, s47, v234
    v_add_u32 v235, s47, v235
    ds_read_b64_tr_b16 v[96:97], v232 offset:0
    ds_read_b64_tr_b16 v[98:99], v232 offset:2048
    ds_read_b64_tr_b16 v[100:101], v233 offset:0
    ds_read_b64_tr_b16 v[102:103], v233 offset:2048
    ds_read_b64_tr_b16 v[104:105], v234 offset:0
    ds_read_b64_tr_b16 v[106:107], v234 offset:2048
    ds_read_b64_tr_b16 v[108:109], v235 offset:0
    ds_read_b64_tr_b16 v[110:111], v235 offset:2048
    ds_read_b64_tr_b16 v[112:113], v232 offset:4096
    ds_read_b64_tr_b16 v[114:115], v232 offset:6144
    ds_read_b64_tr_b16 v[116:117], v233 offset:4096
    ds_read_b64_tr_b16 v[118:119], v233 offset:6144
    ds_read_b64_tr_b16 v[120:121], v234 offset:4096
    ds_read_b64_tr_b16 v[122:123], v234 offset:6144
    ds_read_b64_tr_b16 v[124:125], v235 offset:4096
    ds_read_b64_tr_b16 v[126:127], v235 offset:6144
    s_waitcnt lgkmcnt(0)
    v_lshl_or_b32 v229, v209, 1, v208
    v_lshl_or_b32 v229, v210, 2, v229
    v_lshl_or_b32 v229, v211, 3, v229
    s_nop 0
    v_readfirstlane_b32 s54, v229
    s_and_b32 s54, s54, s53
    s_mov_b32 s58, 0
    s_cmp_lg_u32 s54, 0
    s_cbranch_scc0 L_dy_p0
    s_ff1_i32_b32 s44, s54
    s_bitset0_b32 s54, s44
    s_bitset0_b32 s53, s44
    s_xor_b32 s55, s44, 2
    s_add_u32 s70, s55, s79
    s_add_u32 s70, s70, 16
    s_lshl_b32 s46, s70, 13
    s_add_u32 s46, s46, s97
    buffer_load_dwordx4 v[176:179], v228, s[20:23], s46 offen offset:0 sc1
    buffer_load_dwordx4 v[180:183], v228, s[20:23], s46 offen offset:1024 sc1
    buffer_load_dwordx4 v[184:187], v228, s[20:23], s46 offen offset:2048 sc1
    buffer_load_dwordx4 v[188:191], v228, s[20:23], s46 offen offset:3072 sc1
    s_add_u32 s46, s46, 4096
    buffer_load_dwordx4 v[192:195], v228, s[20:23], s46 offen offset:0 sc1
    buffer_load_dwordx4 v[196:199], v228, s[20:23], s46 offen offset:1024 sc1
    buffer_load_dwordx4 v[200:203], v228, s[20:23], s46 offen offset:2048 sc1
    buffer_load_dwordx4 v[204:207], v228, s[20:23], s46 offen offset:3072 sc1
    s_mov_b32 s58, 1
L_dy_p0:
    buffer_load_dwordx4 v[208:211], off, s[20:23], s59 offset:64 sc1
    v_mfma_f32_32x32x16_bf16 v[0:15], v[96:99], v[144:147], v[0:15]
    ds_read_b64_tr_b16 v[128:129], v232 offset:8192
    ds_read_b64_tr_b16 v[130:131], v232 offset:10240
    v_mfma_f32_32x32x16_bf16 v[16:31], v[100:103], v[144:147], v[16:31]
    ds_read_b64_tr_b16 v[132:133], v233 offset:8192
    ds_read_b64_tr_b16 v[134:135], v233 offset:10240
    v_mfma_f32_32x32x16_bf16 v[32:47], v[104:107], v[144:147], v[32:47]
    ds_read_b64_tr_b16 v[136:137], v234 offset:8192
    ds_read_b64_tr_b16 v[138:139], v234 offset:10240
    v_mfma_f32_32x32x16_bf16 v[48:63], v[108:111], v[144:147], v[48:63]
    ds_read_b64_tr_b16 v[140:141], v235 offset:8192
    ds_read_b64_tr_b16 v[142:143], v235 offset:10240
    v_mfma_f32_32x32x16_bf16 v[0:15], v[112:115], v[148:151], v[0:15]
    ds_read_b64_tr_b16 v[96:97], v232 offset:12288
    ds_read_b64_tr_b16 v[98:99], v232 offset:14336
    v_mfma_f32_32x32x16_bf16 v[16:31], v[116:119], v[148:151], v[16:31]
    ds_read_b64_tr_b16 v[100:101], v233 offset:12288
    ds_read_b64_tr_b16 v[102:103], v233 offset:14336
    v_mfma_f32_32x32x16_bf16 v[32:47], v[120:123], v[148:151], v[32:47]
    ds_read_b64_tr_b16 v[104:105], v234 offset:12288
    ds_read_b64_tr_b16 v[106:107], v234 offset:14336
    v_mfma_f32_32x32x16_bf16 v[48:63], v[124:127], v[148:151], v[48:63]
    ds_read_b64_tr_b16 v[108:109], v235 offset:12288
    ds_read_b64_tr_b16 v[110:111], v235 offset:14336
    s_waitcnt lgkmcnt(14)
    v_mfma_f32_32x32x16_bf16 v[0:15], v[128:131], v[152:155], v[0:15]
    ds_read_b64_tr_b16 v[112:113], v232 offset:16384
    ds_read_b64_tr_b16 v[114:115], v232 offset:18432
    s_waitcnt lgkmcnt(14)
    v_mfma_f32_32x32x16_bf16 v[16:31], v[132:135], v[152:155], v[16:31]
    ds_read_b64_tr_b16 v[116:117], v233 offset:16384
    ds_read_b64_tr_b16 v[118:119], v233 offset:18432
    s_waitcnt lgkmcnt(14)
    v_mfma_f32_32x32x16_bf16 v[32:47], v[136:139], v[152:155], v[32:47]
    ds_read_b64_tr_b16 v[120:121], v234 offset:16384
    ds_read_b64_tr_b16 v[122:123], v234 offset:18432
    s_waitcnt lgkmcnt(14)
    v_mfma_f32_32x32x16_bf16 v[48:63], v[140:143], v[152:155], v[48:63]
    ds_read_b64_tr_b16 v[124:125], v235 offset:16384
    ds_read_b64_tr_b16 v[126:127], v235 offset:18432
    s_waitcnt lgkmcnt(14)
    v_mfma_f32_32x32x16_bf16 v[0:15], v[96:99], v[156:159], v[0:15]
    ds_read_b64_tr_b16 v[128:129], v232 offset:20480
    ds_read_b64_tr_b16 v[130:131], v232 offset:22528
    s_waitcnt lgkmcnt(14)
    v_mfma_f32_32x32x16_bf16 v[16:31], v[100:103], v[156:159], v[16:31]
    ds_read_b64_tr_b16 v[132:133], v233 offset:20480
    ds_read_b64_tr_b16 v[134:135], v233 offset:22528
    s_waitcnt lgkmcnt(14)
    v_mfma_f32_32x32x16_bf16 v[32:47], v[104:107], v[156:159], v[32:47]
    ds_read_b64_tr_b16 v[136:137], v234 offset:20480
    ds_read_b64_tr_b16 v[138:139], v234 offset:22528
    s_waitcnt lgkmcnt(14)
    v_mfma_f32_32x32x16_bf16 v[48:63], v[108:111], v[156:159], v[48:63]
    ds_read_b64_tr_b16 v[140:141], v235 offset:20480
    ds_read_b64_tr_b16 v[142:143], v235 offset:22528
    s_waitcnt lgkmcnt(14)
    v_mfma_f32_32x32x16_bf16 v[0:15], v[112:115], v[160:163], v[0:15]
    ds_read_b64_tr_b16 v[96:97], v232 offset:24576
    ds_read_b64_tr_b16 v[98:99], v232 offset:26624
    s_waitcnt lgkmcnt(14)
    v_mfma_f32_32x32x16_bf16 v[16:31], v[116:119], v[160:163], v[16:31]
    ds_read_b64_tr_b16 v[100:101], v233 offset:24576
    ds_read_b64_tr_b16 v[102:103], v233 offset:26624
    s_waitcnt lgkmcnt(14)
    v_mfma_f32_32x32x16_bf16 v[32:47], v[120:123], v[160:163], v[32:47]
    ds_read_b64_tr_b16 v[104:105], v234 offset:24576
    ds_read_b64_tr_b16 v[106:107], v234 offset:26624
    s_waitcnt lgkmcnt(14)
    v_mfma_f32_32x32x16_bf16 v[48:63], v[124:127], v[160:163], v[48:63]
    ds_read_b64_tr_b16 v[108:109], v235 offset:24576
    ds_read_b64_tr_b16 v[110:111], v235 offset:26624
    s_waitcnt lgkmcnt(14)
    v_mfma_f32_32x32x16_bf16 v[0:15], v[128:131], v[164:167], v[0:15]
    ds_read_b64_tr_b16 v[112:113], v232 offset:28672
    ds_read_b64_tr_b16 v[114:115], v232 offset:30720
    s_waitcnt lgkmcnt(14)
    v_mfma_f32_32x32x16_bf16 v[16:31], v[132:135], v[164:167], v[16:31]
    ds_read_b64_tr_b16 v[116:117], v233 offset:28672
    ds_read_b64_tr_b16 v[118:119], v233 offset:30720
    s_waitcnt lgkmcnt(14)
    v_mfma_f32_32x32x16_bf16 v[32:47], v[136:139], v[164:167], v[32:47]
    ds_read_b64_tr_b16 v[120:121], v234 offset:28672
    ds_read_b64_tr_b16 v[122:123], v234 offset:30720
    s_waitcnt lgkmcnt(14)
    v_mfma_f32_32x32x16_bf16 v[48:63], v[140:143], v[164:167], v[48:63]
    ds_read_b64_tr_b16 v[124:125], v235 offset:28672
    ds_read_b64_tr_b16 v[126:127], v235 offset:30720
    s_waitcnt lgkmcnt(14)
    v_mfma_f32_32x32x16_bf16 v[0:15], v[96:99], v[168:171], v[0:15]
    s_waitcnt lgkmcnt(12)
    v_mfma_f32_32x32x16_bf16 v[16:31], v[100:103], v[168:171], v[16:31]
    s_waitcnt lgkmcnt(10)
    v_mfma_f32_32x32x16_bf16 v[32:47], v[104:107], v[168:171], v[32:47]
    s_waitcnt lgkmcnt(8)
    v_mfma_f32_32x32x16_bf16 v[48:63], v[108:111], v[168:171], v[48:63]
    s_waitcnt lgkmcnt(6)
    v_mfma_f32_32x32x16_bf16 v[0:15], v[112:115], v[172:175], v[0:15]
    s_waitcnt lgkmcnt(4)
    v_mfma_f32_32x32x16_bf16 v[16:31], v[116:119], v[172:175], v[16:31]
    s_waitcnt lgkmcnt(2)
    v_mfma_f32_32x32x16_bf16 v[32:47], v[120:123], v[172:175], v[32:47]
    s_waitcnt lgkmcnt(0)
    v_mfma_f32_32x32x16_bf16 v[48:63], v[124:127], v[172:175], v[48:63]
    s_cmp_eq_u32 s58, 0
    s_cbranch_scc0 L_d0_skip
    s_waitcnt vmcnt(0)
    v_lshl_or_b32 v229, v209, 1, v208
    v_lshl_or_b32 v229, v210, 2, v229
    v_lshl_or_b32 v229, v211, 3, v229
    s_nop 0
    v_readfirstlane_b32 s54, v229
    s_and_b32 s54, s54, s53
    s_mov_b32 s96, 400000
L_ds_s0:
    s_cmp_lg_u32 s54, 0
    s_cbranch_scc1 L_dd_s0
    buffer_load_dwordx4 v[208:211], off, s[20:23], s59 offset:64 sc1
    s_waitcnt vmcnt(0)
    v_lshl_or_b32 v229, v209, 1, v208
    v_lshl_or_b32 v229, v210, 2, v229
    v_lshl_or_b32 v229, v211, 3, v229
    s_nop 0
    v_readfirstlane_b32 s54, v229
    s_and_b32 s54, s54, s53
    s_sub_u32 s96, s96, 1
    s_cbranch_scc0 L_ds_s0
    s_mov_b32 s54, s53
L_dd_s0:
    s_ff1_i32_b32 s44, s54
    s_bitset0_b32 s54, s44
    s_bitset0_b32 s53, s44
    s_xor_b32 s55, s44, 2
    s_add_u32 s70, s55, s79
    s_add_u32 s70, s70, 16
    s_lshl_b32 s46, s70, 13
    s_add_u32 s46, s46, s97
    buffer_load_dwordx4 v[176:179], v228, s[20:23], s46 offen offset:0 sc1
    buffer_load_dwordx4 v[180:183], v228, s[20:23], s46 offen offset:1024 sc1
    buffer_load_dwordx4 v[184:187], v228, s[20:23], s46 offen offset:2048 sc1
    buffer_load_dwordx4 v[188:191], v228, s[20:23], s46 offen offset:3072 sc1
    s_add_u32 s46, s46, 4096
    buffer_load_dwordx4 v[192:195], v228, s[20:23], s46 offen offset:0 sc1
    buffer_load_dwordx4 v[196:199], v228, s[20:23], s46 offen offset:1024 sc1
    buffer_load_dwordx4 v[200:203], v228, s[20:23], s46 offen offset:2048 sc1
    buffer_load_dwordx4 v[204:207], v228, s[20:23], s46 offen offset:3072 sc1
    s_mov_b32 s58, 1
    s_cmp_lg_u32 s54, 0
    s_cbranch_scc0 L_dy_s01
    s_ff1_i32_b32 s44, s54
    s_bitset0_b32 s54, s44
    s_bitset0_b32 s53, s44
    s_xor_b32 s56, s44, 2
    s_add_u32 s70, s56, s79
    s_add_u32 s70, s70, 16
    s_lshl_b32 s46, s70, 13
    s_add_u32 s46, s46, s97
    buffer_load_dwordx4 v[64:67], v228, s[20:23], s46 offen offset:0 sc1
    buffer_load_dwordx4 v[68:71], v228, s[20:23], s46 offen offset:1024 sc1
    buffer_load_dwordx4 v[72:75], v228, s[20:23], s46 offen offset:2048 sc1
    buffer_load_dwordx4 v[76:79], v228, s[20:23], s46 offen offset:3072 sc1
    s_add_u32 s46, s46, 4096
    buffer_load_dwordx4 v[80:83], v228, s[20:23], s46 offen offset:0 sc1
    buffer_load_dwordx4 v[84:87], v228, s[20:23], s46 offen offset:1024 sc1
    buffer_load_dwordx4 v[88:91], v228, s[20:23], s46 offen offset:2048 sc1
    buffer_load_dwordx4 v[92:95], v228, s[20:23], s46 offen offset:3072 sc1
    s_mov_b32 s58, 2
L_dy_s01:
    buffer_load_dwordx4 v[208:211], off, s[20:23], s59 offset:64 sc1
L_d0_skip:
    s_cmp_eq_u32 s58, 2
    s_cbranch_scc0 L_dy_s02
    s_cmp_lg_u32 s54, 0
    s_cbranch_scc0 L_dy_s02
    s_ff1_i32_b32 s44, s54
    s_bitset0_b32 s54, s44
    s_bitset0_b32 s53, s44
    s_xor_b32 s57, s44, 2
    s_add_u32 s70, s57, s79
    s_add_u32 s70, s70, 16
    s_lshl_b32 s46, s70, 13
    s_add_u32 s46, s46, s97
    buffer_load_dwordx4 v[144:147], v228, s[20:23], s46 offen offset:0 sc1
    buffer_load_dwordx4 v[148:151], v228, s[20:23], s46 offen offset:1024 sc1
    buffer_load_dwordx4 v[152:155], v228, s[20:23], s46 offen offset:2048 sc1
    buffer_load_dwordx4 v[156:159], v228, s[20:23], s46 offen offset:3072 sc1
    s_add_u32 s46, s46, 4096
    buffer_load_dwordx4 v[160:163], v228, s[20:23], s46 offen offset:0 sc1
    buffer_load_dwordx4 v[164:167], v228, s[20:23], s46 offen offset:1024 sc1
    buffer_load_dwordx4 v[168:171], v228, s[20:23], s46 offen offset:2048 sc1
    buffer_load_dwordx4 v[172:175], v228, s[20:23], s46 offen offset:3072 sc1
    s_mov_b32 s58, 3
L_dy_s02:
    s_sub_u32 s47, s55, s27
    s_and_b32 s47, s47, 3
    s_lshl_b32 s47, s47, 2
    s_lshr_b32 s47, 8980, s47
    s_and_b32 s47, s47, 7
    s_lshl_b32 s46, s47, 15
    s_sub_u32 s47, s46, s99
    s_mov_b32 s99, s46
    v_add_u32 v232, s47, v232
    v_add_u32 v233, s47, v233
    v_add_u32 v234, s47, v234
    v_add_u32 v235, s47, v235
    ds_read_b64_tr_b16 v[96:97], v232 offset:0
    ds_read_b64_tr_b16 v[98:99], v232 offset:2048
    ds_read_b64_tr_b16 v[100:101], v233 offset:0
    ds_read_b64_tr_b16 v[102:103], v233 offset:2048
    ds_read_b64_tr_b16 v[104:105], v234 offset:0
    ds_read_b64_tr_b16 v[106:107], v234 offset:2048
    ds_read_b64_tr_b16 v[108:109], v235 offset:0
    ds_read_b64_tr_b16 v[110:111], v235 offset:2048
    ds_read_b64_tr_b16 v[112:113], v232 offset:4096
    ds_read_b64_tr_b16 v[114:115], v232 offset:6144
    ds_read_b64_tr_b16 v[116:117], v233 offset:4096
    ds_read_b64_tr_b16 v[118:119], v233 offset:6144
    ds_read_b64_tr_b16 v[120:121], v234 offset:4096
    ds_read_b64_tr_b16 v[122:123], v234 offset:6144
    ds_read_b64_tr_b16 v[124:125], v235 offset:4096
    ds_read_b64_tr_b16 v[126:127], v235 offset:6144
    s_cmp_eq_u32 s58, 3
    s_cbranch_scc1 L_w0_3
    s_cmp_eq_u32 s58, 2
    s_cbranch_scc1 L_w0_2
    s_waitcnt vmcnt(1)
    s_branch L_w0_d
L_w0_2:
    s_waitcnt vmcnt(9)
    s_branch L_w0_d
L_w0_3:
    s_waitcnt vmcnt(17)
L_w0_d:
    s_waitcnt lgkmcnt(14)
    v_mfma_f32_32x32x16_bf16 v[0:15], v[96:99], v[176:179], v[0:15]
    ds_read_b64_tr_b16 v[128:129], v232 offset:8192
    ds_read_b64_tr_b16 v[130:131], v232 offset:10240
    s_waitcnt lgkmcnt(14)
    v_mfma_f32_32x32x16_bf16 v[16:31], v[100:103], v[176:179], v[16:31]
    ds_read_b64_tr_b16 v[132:133], v233 offset:8192
    ds_read_b64_tr_b16 v[134:135], v233 offset:10240
    s_waitcnt lgkmcnt(14)
    v_mfma_f32_32x32x16_bf16 v[32:47], v[104:107], v[176:179], v[32:47]
    ds_read_b64_tr_b16 v[136:137], v234 offset:8192
    ds_read_b64_tr_b16 v[138:139], v234 offset:10240
    s_waitcnt lgkmcnt(14)
    v_mfma_f32_32x32x16_bf16 v[48:63], v[108:111], v[176:179], v[48:63]
    ds_read_b64_tr_b16 v[140:141], v235 offset:8192
    ds_read_b64_tr_b16 v[142:143], v235 offset:10240
    s_waitcnt lgkmcnt(14)
    v_mfma_f32_32x32x16_bf16 v[0:15], v[112:115], v[180:183], v[0:15]
    ds_read_b64_tr_b16 v[96:97], v232 offset:12288
    ds_read_b64_tr_b16 v[98:99], v232 offset:14336
    s_waitcnt lgkmcnt(14)
    v_mfma_f32_32x32x16_bf16 v[16:31], v[116:119], v[180:183], v[16:31]
    ds_read_b64_tr_b16 v[100:101], v233 offset:12288
    ds_read_b64_tr_b16 v[102:103], v233 offset:14336
    s_waitcnt lgkmcnt(14)
    v_mfma_f32_32x32x16_bf16 v[32:47], v[120:123], v[180:183], v[32:47]
    ds_read_b64_tr_b16 v[104:105], v234 offset:12288
    ds_read_b64_tr_b16 v[106:107], v234 offset:14336
    s_waitcnt lgkmcnt(14)
    v_mfma_f32_32x32x16_bf16 v[48:63], v[124:127], v[180:183], v[48:63]
    ds_read_b64_tr_b16 v[108:109], v235 offset:12288
    ds_read_b64_tr_b16 v[110:111], v235 offset:14336
    s_waitcnt lgkmcnt(14)
    v_mfma_f32_32x32x16_bf16 v[0:15], v[128:131], v[184:187], v[0:15]
    ds_read_b64_tr_b16 v[112:113], v232 offset:16384
    ds_read_b64_tr_b16 v[114:115], v232 offset:18432
    s_waitcnt lgkmcnt(14)
    v_mfma_f32_32x32x16_bf16 v[16:31], v[132:135], v[184:187], v[16:31]
    ds_read_b64_tr_b16 v[116:117], v233 offset:16384
    ds_read_b64_tr_b16 v[118:119], v233 offset:18432
    s_waitcnt lgkmcnt(14)
    v_mfma_f32_32x32x16_bf16 v[32:47], v[136:139], v[184:187], v[32:47]
    ds_read_b64_tr_b16 v[120:121], v234 offset:16384
    ds_read_b64_tr_b16 v[122:123], v234 offset:18432
    s_waitcnt lgkmcnt(14)
    v_mfma_f32_32x32x16_bf16 v[48:63], v[140:143], v[184:187], v[48:63]
    ds_read_b64_tr_b16 v[124:125], v235 offset:16384
    ds_read_b64_tr_b16 v[126:127], v235 offset:18432
    s_waitcnt lgkmcnt(14)
    v_mfma_f32_32x32x16_bf16 v[0:15], v[96:99], v[188:191], v[0:15]
    ds_read_b64_tr_b16 v[128:129], v232 offset:20480
    ds_read_b64_tr_b16 v[130:131], v232 offset:22528
    s_waitcnt lgkmcnt(14)
    v_mfma_f32_32x32x16_bf16 v[16:31], v[100:103], v[188:191], v[16:31]
    ds_read_b64_tr_b16 v[132:133], v233 offset:20480
    ds_read_b64_tr_b16 v[134:135], v233 offset:22528
    s_waitcnt lgkmcnt(14)
    v_mfma_f32_32x32x16_bf16 v[32:47], v[104:107], v[188:191], v[32:47]
    ds_read_b64_tr_b16 v[136:137], v234 offset:20480
    ds_read_b64_tr_b16 v[138:139], v234 offset:22528
    s_waitcnt lgkmcnt(14)
    v_mfma_f32_32x32x16_bf16 v[48:63], v[108:111], v[188:191], v[48:63]
    ds_read_b64_tr_b16 v[140:141], v235 offset:20480
    ds_read_b64_tr_b16 v[142:143], v235 offset:22528
    s_waitcnt lgkmcnt(14)
    v_mfma_f32_32x32x16_bf16 v[0:15], v[112:115], v[192:195], v[0:15]
    ds_read_b64_tr_b16 v[96:97], v232 offset:24576
    ds_read_b64_tr_b16 v[98:99], v232 offset:26624
    s_waitcnt lgkmcnt(14)
    v_mfma_f32_32x32x16_bf16 v[16:31], v[116:119], v[192:195], v[16:31]
    ds_read_b64_tr_b16 v[100:101], v233 offset:24576
    ds_read_b64_tr_b16 v[102:103], v233 offset:26624
    s_waitcnt lgkmcnt(14)
    v_mfma_f32_32x32x16_bf16 v[32:47], v[120:123], v[192:195], v[32:47]
    ds_read_b64_tr_b16 v[104:105], v234 offset:24576
    ds_read_b64_tr_b16 v[106:107], v234 offset:26624
    s_waitcnt lgkmcnt(14)
    v_mfma_f32_32x32x16_bf16 v[48:63], v[124:127], v[192:195], v[48:63]
    ds_read_b64_tr_b16 v[108:109], v235 offset:24576
    ds_read_b64_tr_b16 v[110:111], v235 offset:26624
    s_waitcnt lgkmcnt(14)
    v_mfma_f32_32x32x16_bf16 v[0:15], v[128:131], v[196:199], v[0:15]
    ds_read_b64_tr_b16 v[112:113], v232 offset:28672
    ds_read_b64_tr_b16 v[114:115], v232 offset:30720
    s_waitcnt lgkmcnt(14)
    v_mfma_f32_32x32x16_bf16 v[16:31], v[132:135], v[196:199], v[16:31]
    ds_read_b64_tr_b16 v[116:117], v233 offset:28672
    ds_read_b64_tr_b16 v[118:119], v233 offset:30720
    s_waitcnt lgkmcnt(14)
    v_mfma_f32_32x32x16_bf16 v[32:47], v[136:139], v[196:199], v[32:47]
    ds_read_b64_tr_b16 v[120:121], v234 offset:28672
    ds_read_b64_tr_b16 v[122:123], v234 offset:30720
    s_waitcnt lgkmcnt(14)
    v_mfma_f32_32x32x16_bf16 v[48:63], v[140:143], v[196:199], v[48:63]
    ds_read_b64_tr_b16 v[124:125], v235 offset:28672
    ds_read_b64_tr_b16 v[126:127], v235 offset:30720
    s_waitcnt lgkmcnt(14)
    v_mfma_f32_32x32x16_bf16 v[0:15], v[96:99], v[200:203], v[0:15]
    s_waitcnt lgkmcnt(12)
    v_mfma_f32_32x32x16_bf16 v[16:31], v[100:103], v[200:203], v[16:31]
    s_waitcnt lgkmcnt(10)
    v_mfma_f32_32x32x16_bf16 v[32:47], v[104:107], v[200:203], v[32:47]
    s_waitcnt lgkmcnt(8)
    v_mfma_f32_32x32x16_bf16 v[48:63], v[108:111], v[200:203], v[48:63]
    s_waitcnt lgkmcnt(6)
    v_mfma_f32_32x32x16_bf16 v[0:15], v[112:115], v[204:207], v[0:15]
    s_waitcnt lgkmcnt(4)
    v_mfma_f32_32x32x16_bf16 v[16:31], v[116:119], v[204:207], v[16:31]
    s_waitcnt lgkmcnt(2)
    v_mfma_f32_32x32x16_bf16 v[32:47], v[120:123], v[204:207], v[32:47]
    s_waitcnt lgkmcnt(0)
    v_mfma_f32_32x32x16_bf16 v[48:63], v[124:127], v[204:207], v[48:63]
    s_mov_b32 s60, 9
    s_cmp_eq_u32 s58, 3
    s_cbranch_scc1 L_d1_go
    s_waitcnt vmcnt(0)
    v_lshl_or_b32 v229, v209, 1, v208
    v_lshl_or_b32 v229, v210, 2, v229
    v_lshl_or_b32 v229, v211, 3, v229
    s_nop 0
    v_readfirstlane_b32 s54, v229
    s_and_b32 s54, s54, s53
    s_cmp_eq_u32 s58, 2
    s_cbranch_scc1 L_d1_two
    s_mov_b32 s96, 400000
L_ds_s1:
    s_cmp_lg_u32 s54, 0
    s_cbranch_scc1 L_dd_s1
    buffer_load_dwordx4 v[208:211], off, s[20:23], s59 offset:64 sc1
    s_waitcnt vmcnt(0)
    v_lshl_or_b32 v229, v209, 1, v208
    v_lshl_or_b32 v229, v210, 2, v229
    v_lshl_or_b32 v229, v211, 3, v229
    s_nop 0
    v_readfirstlane_b32 s54, v229
    s_and_b32 s54, s54, s53
    s_sub_u32 s96, s96, 1
    s_cbranch_scc0 L_ds_s1
    s_mov_b32 s54, s53
L_dd_s1:
    s_ff1_i32_b32 s44, s54
    s_bitset0_b32 s54, s44
    s_bitset0_b32 s53, s44
    s_xor_b32 s56, s44, 2
    s_add_u32 s70, s56, s79
    s_add_u32 s70, s70, 16
    s_lshl_b32 s46, s70, 13
    s_add_u32 s46, s46, s97
    buffer_load_dwordx4 v[64:67], v228, s[20:23], s46 offen offset:0 sc1
    buffer_load_dwordx4 v[68:71], v228, s[20:23], s46 offen offset:1024 sc1
    buffer_load_dwordx4 v[72:75], v228, s[20:23], s46 offen offset:2048 sc1
    buffer_load_dwordx4 v[76:79], v228, s[20:23], s46 offen offset:3072 sc1
    s_add_u32 s46, s46, 4096
    buffer_load_dwordx4 v[80:83], v228, s[20:23], s46 offen offset:0 sc1
    buffer_load_dwordx4 v[84:87], v228, s[20:23], s46 offen offset:1024 sc1
    buffer_load_dwordx4 v[88:91], v228, s[20:23], s46 offen offset:2048 sc1
    buffer_load_dwordx4 v[92:95], v228, s[20:23], s46 offen offset:3072 sc1
    s_mov_b32 s58, 2
    s_cmp_lg_u32 s54, 0
    s_cbranch_scc0 L_dy_s12
    s_ff1_i32_b32 s44, s54
    s_bitset0_b32 s54, s44
    s_bitset0_b32 s53, s44
    s_xor_b32 s57, s44, 2
    s_add_u32 s70, s57, s79
    s_add_u32 s70, s70, 16
    s_lshl_b32 s46, s70, 13
    s_add_u32 s46, s46, s97
    buffer_load_dwordx4 v[144:147], v228, s[20:23], s46 offen offset:0 sc1
    buffer_load_dwordx4 v[148:151], v228, s[20:23], s46 offen offset:1024 sc1
    buffer_load_dwordx4 v[152:155], v228, s[20:23], s46 offen offset:2048 sc1
    buffer_load_dwordx4 v[156:159], v228, s[20:23], s46 offen offset:3072 sc1
    s_add_u32 s46, s46, 4096
    buffer_load_dwordx4 v[160:163], v228, s[20:23], s46 offen offset:0 sc1
    buffer_load_dwordx4 v[164:167], v228, s[20:23], s46 offen offset:1024 sc1
    buffer_load_dwordx4 v[168:171], v228, s[20:23], s46 offen offset:2048 sc1
    buffer_load_dwordx4 v[172:175], v228, s[20:23], s46 offen offset:3072 sc1
    s_mov_b32 s58, 3
L_dy_s12:
    buffer_load_dwordx4 v[208:211], off, s[20:23], s59 offset:64 sc1
    s_cmp_eq_u32 s58, 2
    s_cselect_b32 s60, 1, 9
    s_branch L_d1_go
L_d1_two:
    s_cmp_lg_u32 s54, 0
    s_cbranch_scc0 L_dy_s13
    s_ff1_i32_b32 s44, s54
    s_bitset0_b32 s54, s44
    s_bitset0_b32 s53, s44
    s_xor_b32 s57, s44, 2
    s_add_u32 s70, s57, s79
    s_add_u32 s70, s70, 16
    s_lshl_b32 s46, s70, 13
    s_add_u32 s46, s46, s97
    buffer_load_dwordx4 v[144:147], v228, s[20:23], s46 offen offset:0 sc1
    buffer_load_dwordx4 v[148:151], v228, s[20:23], s46 offen offset:1024 sc1
    buffer_load_dwordx4 v[152:155], v228, s[20:23], s46 offen offset:2048 sc1
    buffer_load_dwordx4 v[156:159], v228, s[20:23], s46 offen offset:3072 sc1
    s_add_u32 s46, s46, 4096
    buffer_load_dwordx4 v[160:163], v228, s[20:23], s46 offen offset:0 sc1
    buffer_load_dwordx4 v[164:167], v228, s[20:23], s46 offen offset:1024 sc1
    buffer_load_dwordx4 v[168:171], v228, s[20:23], s46 offen offset:2048 sc1
    buffer_load_dwordx4 v[172:175], v228, s[20:23], s46 offen offset:3072 sc1
    s_mov_b32 s58, 3
L_dy_s13:
L_d1_go:
    s_sub_u32 s47, s56, s27
    s_and_b32 s47, s47, 3
    s_lshl_b32 s47, s47, 2
    s_lshr_b32 s47, 8980, s47
    s_and_b32 s47, s47, 7
    s_lshl_b32 s46, s47, 15
    s_sub_u32 s47, s46, s99
    s_mov_b32 s99, s46
    v_add_u32 v232, s47, v232
    v_add_u32 v233, s47, v233
    v_add_u32 v234, s47, v234
    v_add_u32 v235, s47, v235
    ds_read_b64_tr_b16 v[96:97], v232 offset:0
    ds_read_b64_tr_b16 v[98:99], v232 offset:2048
    ds_read_b64_tr_b16 v[100:101], v233 offset:0
    ds_read_b64_tr_b16 v[102:103], v233 offset:2048
    ds_read_b64_tr_b16 v[104:105], v234 offset:0
    ds_read_b64_tr_b16 v[106:107], v234 offset:2048
    ds_read_b64_tr_b16 v[108:109], v235 offset:0
    ds_read_b64_tr_b16 v[110:111], v235 offset:2048
    ds_read_b64_tr_b16 v[112:113], v232 offset:4096
    ds_read_b64_tr_b16 v[114:115], v232 offset:6144
    ds_read_b64_tr_b16 v[116:117], v233 offset:4096
    ds_read_b64_tr_b16 v[118:119], v233 offset:6144
    ds_read_b64_tr_b16 v[120:121], v234 offset:4096
    ds_read_b64_tr_b16 v[122:123], v234 offset:6144
    ds_read_b64_tr_b16 v[124:125], v235 offset:4096
    ds_read_b64_tr_b16 v[126:127], v235 offset:6144
    s_cmp_eq_u32 s60, 1
    s_cbranch_scc1 L_w1_1
    s_waitcnt vmcnt(9)
    s_branch L_w1_d
L_w1_1:
    s_waitcnt vmcnt(1)
L_w1_d:
    s_waitcnt lgkmcnt(14)
    v_mfma_f32_32x32x16_bf16 v[0:15], v[96:99], v[64:67], v[0:15]
    ds_read_b64_tr_b16 v[128:129], v232 offset:8192
    ds_read_b64_tr_b16 v[130:131], v232 offset:10240
    s_waitcnt lgkmcnt(14)
    v_mfma_f32_32x32x16_bf16 v[16:31], v[100:103], v[64:67], v[16:31]
    ds_read_b64_tr_b16 v[132:133], v233 offset:8192
    ds_read_b64_tr_b16 v[134:135], v233 offset:10240
    s_waitcnt lgkmcnt(14)
    v_mfma_f32_32x32x16_bf16 v[32:47], v[104:107], v[64:67], v[32:47]
    ds_read_b64_tr_b16 v[136:137], v234 offset:8192
    ds_read_b64_tr_b16 v[138:139], v234 offset:10240
    s_waitcnt lgkmcnt(14)
    v_mfma_f32_32x32x16_bf16 v[48:63], v[108:111], v[64:67], v[48:63]
    ds_read_b64_tr_b16 v[140:141], v235 offset:8192
    ds_read_b64_tr_b16 v[142:143], v235 offset:10240
    s_waitcnt lgkmcnt(14)
    v_mfma_f32_32x32x16_bf16 v[0:15], v[112:115], v[68:71], v[0:15]
    ds_read_b64_tr_b16 v[96:97], v232 offset:12288
    ds_read_b64_tr_b16 v[98:99], v232 offset:14336
    s_waitcnt lgkmcnt(14)
    v_mfma_f32_32x32x16_bf16 v[16:31], v[116:119], v[68:71], v[16:31]
    ds_read_b64_tr_b16 v[100:101], v233 offset:12288
    ds_read_b64_tr_b16 v[102:103], v233 offset:14336
    s_waitcnt lgkmcnt(14)
    v_mfma_f32_32x32x16_bf16 v[32:47], v[120:123], v[68:71], v[32:47]
    ds_read_b64_tr_b16 v[104:105], v234 offset:12288
    ds_read_b64_tr_b16 v[106:107], v234 offset:14336
    s_waitcnt lgkmcnt(14)
    v_mfma_f32_32x32x16_bf16 v[48:63], v[124:127], v[68:71], v[48:63]
    ds_read_b64_tr_b16 v[108:109], v235 offset:12288
    ds_read_b64_tr_b16 v[110:111], v235 offset:14336
    s_waitcnt lgkmcnt(14)
    v_mfma_f32_32x32x16_bf16 v[0:15], v[128:131], v[72:75], v[0:15]
    ds_read_b64_tr_b16 v[112:113], v232 offset:16384
    ds_read_b64_tr_b16 v[114:115], v232 offset:18432
    s_waitcnt lgkmcnt(14)
    v_mfma_f32_32x32x16_bf16 v[16:31], v[132:135], v[72:75], v[16:31]
    ds_read_b64_tr_b16 v[116:117], v233 offset:16384
    ds_read_b64_tr_b16 v[118:119], v233 offset:18432
    s_waitcnt lgkmcnt(14)
    v_mfma_f32_32x32x16_bf16 v[32:47], v[136:139], v[72:75], v[32:47]
    ds_read_b64_tr_b16 v[120:121], v234 offset:16384
    ds_read_b64_tr_b16 v[122:123], v234 offset:18432
    s_waitcnt lgkmcnt(14)
    v_mfma_f32_32x32x16_bf16 v[48:63], v[140:143], v[72:75], v[48:63]
    ds_read_b64_tr_b16 v[124:125], v235 offset:16384
    ds_read_b64_tr_b16 v[126:127], v235 offset:18432
    s_waitcnt lgkmcnt(14)
    v_mfma_f32_32x32x16_bf16 v[0:15], v[96:99], v[76:79], v[0:15]
    ds_read_b64_tr_b16 v[128:129], v232 offset:20480
    ds_read_b64_tr_b16 v[130:131], v232 offset:22528
    s_waitcnt lgkmcnt(14)
    v_mfma_f32_32x32x16_bf16 v[16:31], v[100:103], v[76:79], v[16:31]
    ds_read_b64_tr_b16 v[132:133], v233 offset:20480
    ds_read_b64_tr_b16 v[134:135], v233 offset:22528
    s_waitcnt lgkmcnt(14)
    v_mfma_f32_32x32x16_bf16 v[32:47], v[104:107], v[76:79], v[32:47]
    ds_read_b64_tr_b16 v[136:137], v234 offset:20480
    ds_read_b64_tr_b16 v[138:139], v234 offset:22528
    s_waitcnt lgkmcnt(14)
    v_mfma_f32_32x32x16_bf16 v[48:63], v[108:111], v[76:79], v[48:63]
    ds_read_b64_tr_b16 v[140:141], v235 offset:20480
    ds_read_b64_tr_b16 v[142:143], v235 offset:22528
    s_waitcnt lgkmcnt(14)
    v_mfma_f32_32x32x16_bf16 v[0:15], v[112:115], v[80:83], v[0:15]
    ds_read_b64_tr_b16 v[96:97], v232 offset:24576
    ds_read_b64_tr_b16 v[98:99], v232 offset:26624
    s_waitcnt lgkmcnt(14)
    v_mfma_f32_32x32x16_bf16 v[16:31], v[116:119], v[80:83], v[16:31]
    ds_read_b64_tr_b16 v[100:101], v233 offset:24576
    ds_read_b64_tr_b16 v[102:103], v233 offset:26624
    s_waitcnt lgkmcnt(14)
    v_mfma_f32_32x32x16_bf16 v[32:47], v[120:123], v[80:83], v[32:47]
    ds_read_b64_tr_b16 v[104:105], v234 offset:24576
    ds_read_b64_tr_b16 v[106:107], v234 offset:26624
    s_waitcnt lgkmcnt(14)
    v_mfma_f32_32x32x16_bf16 v[48:63], v[124:127], v[80:83], v[48:63]
    ds_read_b64_tr_b16 v[108:109], v235 offset:24576
    ds_read_b64_tr_b16 v[110:111], v235 offset:26624
    s_waitcnt lgkmcnt(14)
    v_mfma_f32_32x32x16_bf16 v[0:15], v[128:131], v[84:87], v[0:15]
    ds_read_b64_tr_b16 v[112:113], v232 offset:28672
    ds_read_b64_tr_b16 v[114:115], v232 offset:30720
    s_waitcnt lgkmcnt(14)
    v_mfma_f32_32x32x16_bf16 v[16:31], v[132:135], v[84:87], v[16:31]
    ds_read_b64_tr_b16 v[116:117], v233 offset:28672
    ds_read_b64_tr_b16 v[118:119], v233 offset:30720
    s_waitcnt lgkmcnt(14)
    v_mfma_f32_32x32x16_bf16 v[32:47], v[136:139], v[84:87], v[32:47]
    ds_read_b64_tr_b16 v[120:121], v234 offset:28672
    ds_read_b64_tr_b16 v[122:123], v234 offset:30720
    s_waitcnt lgkmcnt(14)
    v_mfma_f32_32x32x16_bf16 v[48:63], v[140:143], v[84:87], v[48:63]
    ds_read_b64_tr_b16 v[124:125], v235 offset:28672
    ds_read_b64_tr_b16 v[126:127], v235 offset:30720
    s_waitcnt lgkmcnt(14)
    v_mfma_f32_32x32x16_bf16 v[0:15], v[96:99], v[88:91], v[0:15]
    s_waitcnt lgkmcnt(12)
    v_mfma_f32_32x32x16_bf16 v[16:31], v[100:103], v[88:91], v[16:31]
    s_waitcnt lgkmcnt(10)
    v_mfma_f32_32x32x16_bf16 v[32:47], v[104:107], v[88:91], v[32:47]
    s_waitcnt lgkmcnt(8)
    v_mfma_f32_32x32x16_bf16 v[48:63], v[108:111], v[88:91], v[48:63]
    s_waitcnt lgkmcnt(6)
    v_mfma_f32_32x32x16_bf16 v[0:15], v[112:115], v[92:95], v[0:15]
    s_waitcnt lgkmcnt(4)
    v_mfma_f32_32x32x16_bf16 v[16:31], v[116:119], v[92:95], v[16:31]
    s_waitcnt lgkmcnt(2)
    v_mfma_f32_32x32x16_bf16 v[32:47], v[120:123], v[92:95], v[32:47]
    s_waitcnt lgkmcnt(0)
    v_mfma_f32_32x32x16_bf16 v[48:63], v[124:127], v[92:95], v[48:63]
    s_cmp_eq_u32 s58, 3
    s_cbranch_scc1 L_d2_go
    s_waitcnt vmcnt(0)
    v_lshl_or_b32 v229, v209, 1, v208
    v_lshl_or_b32 v229, v210, 2, v229
    v_lshl_or_b32 v229, v211, 3, v229
    s_nop 0
    v_readfirstlane_b32 s54, v229
    s_and_b32 s54, s54, s53
    s_mov_b32 s96, 400000
L_ds_s2:
    s_cmp_lg_u32 s54, 0
    s_cbranch_scc1 L_dd_s2
    buffer_load_dwordx4 v[208:211], off, s[20:23], s59 offset:64 sc1
    s_waitcnt vmcnt(0)
    v_lshl_or_b32 v229, v209, 1, v208
    v_lshl_or_b32 v229, v210, 2, v229
    v_lshl_or_b32 v229, v211, 3, v229
    s_nop 0
    v_readfirstlane_b32 s54, v229
    s_and_b32 s54, s54, s53
    s_sub_u32 s96, s96, 1
    s_cbranch_scc0 L_ds_s2
    s_mov_b32 s54, s53
L_dd_s2:
    s_ff1_i32_b32 s44, s54
    s_bitset0_b32 s54, s44
    s_bitset0_b32 s53, s44
    s_xor_b32 s57, s44, 2
    s_add_u32 s70, s57, s79
    s_add_u32 s70, s70, 16
    s_lshl_b32 s46, s70, 13
    s_add_u32 s46, s46, s97
    buffer_load_dwordx4 v[144:147], v228, s[20:23], s46 offen offset:0 sc1
    buffer_load_dwordx4 v[148:151], v228, s[20:23], s46 offen offset:1024 sc1
    buffer_load_dwordx4 v[152:155], v228, s[20:23], s46 offen offset:2048 sc1
    buffer_load_dwordx4 v[156:159], v228, s[20:23], s46 offen offset:3072 sc1
    s_add_u32 s46, s46, 4096
    buffer_load_dwordx4 v[160:163], v228, s[20:23], s46 offen offset:0 sc1
    buffer_load_dwordx4 v[164:167], v228, s[20:23], s46 offen offset:1024 sc1
    buffer_load_dwordx4 v[168:171], v228, s[20:23], s46 offen offset:2048 sc1
    buffer_load_dwordx4 v[172:175], v228, s[20:23], s46 offen offset:3072 sc1
    s_mov_b32 s58, 3
L_d2_go:
    s_sub_u32 s47, s57, s27
    s_and_b32 s47, s47, 3
    s_lshl_b32 s47, s47, 2
    s_lshr_b32 s47, 8980, s47
    s_and_b32 s47, s47, 7
    s_lshl_b32 s46, s47, 15
    s_sub_u32 s47, s46, s99
    s_mov_b32 s99, s46
    v_add_u32 v232, s47, v232
    v_add_u32 v233, s47, v233
    v_add_u32 v234, s47, v234
    v_add_u32 v235, s47, v235
    ds_read_b64_tr_b16 v[96:97], v232 offset:0
    ds_read_b64_tr_b16 v[98:99], v232 offset:2048
    ds_read_b64_tr_b16 v[100:101], v233 offset:0
    ds_read_b64_tr_b16 v[102:103], v233 offset:2048
    ds_read_b64_tr_b16 v[104:105], v234 offset:0
    ds_read_b64_tr_b16 v[106:107], v234 offset:2048
    ds_read_b64_tr_b16 v[108:109], v235 offset:0
    ds_read_b64_tr_b16 v[110:111], v235 offset:2048
    ds_read_b64_tr_b16 v[112:113], v232 offset:4096
    ds_read_b64_tr_b16 v[114:115], v232 offset:6144
    ds_read_b64_tr_b16 v[116:117], v233 offset:4096
    ds_read_b64_tr_b16 v[118:119], v233 offset:6144
    ds_read_b64_tr_b16 v[120:121], v234 offset:4096
    ds_read_b64_tr_b16 v[122:123], v234 offset:6144
    ds_read_b64_tr_b16 v[124:125], v235 offset:4096
    ds_read_b64_tr_b16 v[126:127], v235 offset:6144
    s_waitcnt vmcnt(0)
    s_waitcnt lgkmcnt(14)
    v_mfma_f32_32x32x16_bf16 v[0:15], v[96:99], v[144:147], v[0:15]
    ds_read_b64_tr_b16 v[128:129], v232 offset:8192
    ds_read_b64_tr_b16 v[130:131], v232 offset:10240
    s_waitcnt lgkmcnt(14)
    v_mfma_f32_32x32x16_bf16 v[16:31], v[100:103], v[144:147], v[16:31]
    ds_read_b64_tr_b16 v[132:133], v233 offset:8192
    ds_read_b64_tr_b16 v[134:135], v233 offset:10240
    s_waitcnt lgkmcnt(14)
    v_mfma_f32_32x32x16_bf16 v[32:47], v[104:107], v[144:147], v[32:47]
    ds_read_b64_tr_b16 v[136:137], v234 offset:8192
    ds_read_b64_tr_b16 v[138:139], v234 offset:10240
    s_waitcnt lgkmcnt(14)
    v_mfma_f32_32x32x16_bf16 v[48:63], v[108:111], v[144:147], v[48:63]
    ds_read_b64_tr_b16 v[140:141], v235 offset:8192
    ds_read_b64_tr_b16 v[142:143], v235 offset:10240
    s_waitcnt lgkmcnt(14)
    v_mfma_f32_32x32x16_bf16 v[0:15], v[112:115], v[148:151], v[0:15]
    ds_read_b64_tr_b16 v[96:97], v232 offset:12288
    ds_read_b64_tr_b16 v[98:99], v232 offset:14336
    s_waitcnt lgkmcnt(14)
    v_mfma_f32_32x32x16_bf16 v[16:31], v[116:119], v[148:151], v[16:31]
    ds_read_b64_tr_b16 v[100:101], v233 offset:12288
    ds_read_b64_tr_b16 v[102:103], v233 offset:14336
    s_waitcnt lgkmcnt(14)
    v_mfma_f32_32x32x16_bf16 v[32:47], v[120:123], v[148:151], v[32:47]
    ds_read_b64_tr_b16 v[104:105], v234 offset:12288
    ds_read_b64_tr_b16 v[106:107], v234 offset:14336
    s_waitcnt lgkmcnt(14)
    v_mfma_f32_32x32x16_bf16 v[48:63], v[124:127], v[148:151], v[48:63]
    ds_read_b64_tr_b16 v[108:109], v235 offset:12288
    ds_read_b64_tr_b16 v[110:111], v235 offset:14336
    s_waitcnt lgkmcnt(14)
    v_mfma_f32_32x32x16_bf16 v[0:15], v[128:131], v[152:155], v[0:15]
    ds_read_b64_tr_b16 v[112:113], v232 offset:16384
    ds_read_b64_tr_b16 v[114:115], v232 offset:18432
    s_waitcnt lgkmcnt(14)
    v_mfma_f32_32x32x16_bf16 v[16:31], v[132:135], v[152:155], v[16:31]
    ds_read_b64_tr_b16 v[116:117], v233 offset:16384
    ds_read_b64_tr_b16 v[118:119], v233 offset:18432
    s_waitcnt lgkmcnt(14)
    v_mfma_f32_32x32x16_bf16 v[32:47], v[136:139], v[152:155], v[32:47]
    ds_read_b64_tr_b16 v[120:121], v234 offset:16384
    ds_read_b64_tr_b16 v[122:123], v234 offset:18432
    s_waitcnt lgkmcnt(14)
    v_mfma_f32_32x32x16_bf16 v[48:63], v[140:143], v[152:155], v[48:63]
    ds_read_b64_tr_b16 v[124:125], v235 offset:16384
    ds_read_b64_tr_b16 v[126:127], v235 offset:18432
    s_waitcnt lgkmcnt(14)
    v_mfma_f32_32x32x16_bf16 v[0:15], v[96:99], v[156:159], v[0:15]
    ds_read_b64_tr_b16 v[128:129], v232 offset:20480
    ds_read_b64_tr_b16 v[130:131], v232 offset:22528
    s_waitcnt lgkmcnt(14)
    v_mfma_f32_32x32x16_bf16 v[16:31], v[100:103], v[156:159], v[16:31]
    ds_read_b64_tr_b16 v[132:133], v233 offset:20480
    ds_read_b64_tr_b16 v[134:135], v233 offset:22528
    s_waitcnt lgkmcnt(14)
    v_mfma_f32_32x32x16_bf16 v[32:47], v[104:107], v[156:159], v[32:47]
    ds_read_b64_tr_b16 v[136:137], v234 offset:20480
    ds_read_b64_tr_b16 v[138:139], v234 offset:22528
    s_waitcnt lgkmcnt(14)
    v_mfma_f32_32x32x16_bf16 v[48:63], v[108:111], v[156:159], v[48:63]
    ds_read_b64_tr_b16 v[140:141], v235 offset:20480
    ds_read_b64_tr_b16 v[142:143], v235 offset:22528
    s_waitcnt lgkmcnt(14)
    v_mfma_f32_32x32x16_bf16 v[0:15], v[112:115], v[160:163], v[0:15]
    ds_read_b64_tr_b16 v[96:97], v232 offset:24576
    ds_read_b64_tr_b16 v[98:99], v232 offset:26624
    s_waitcnt lgkmcnt(14)
    v_mfma_f32_32x32x16_bf16 v[16:31], v[116:119], v[160:163], v[16:31]
    ds_read_b64_tr_b16 v[100:101], v233 offset:24576
    ds_read_b64_tr_b16 v[102:103], v233 offset:26624
    s_waitcnt lgkmcnt(14)
    v_mfma_f32_32x32x16_bf16 v[32:47], v[120:123], v[160:163], v[32:47]
    ds_read_b64_tr_b16 v[104:105], v234 offset:24576
    ds_read_b64_tr_b16 v[106:107], v234 offset:26624
    s_waitcnt lgkmcnt(14)
    v_mfma_f32_32x32x16_bf16 v[48:63], v[124:127], v[160:163], v[48:63]
    ds_read_b64_tr_b16 v[108:109], v235 offset:24576
    ds_read_b64_tr_b16 v[110:111], v235 offset:26624
    s_waitcnt lgkmcnt(14)
    v_mfma_f32_32x32x16_bf16 v[0:15], v[128:131], v[164:167], v[0:15]
    ds_read_b64_tr_b16 v[112:113], v232 offset:28672
    ds_read_b64_tr_b16 v[114:115], v232 offset:30720
    s_waitcnt lgkmcnt(14)
    v_mfma_f32_32x32x16_bf16 v[16:31], v[132:135], v[164:167], v[16:31]
    ds_read_b64_tr_b16 v[116:117], v233 offset:28672
    ds_read_b64_tr_b16 v[118:119], v233 offset:30720
    s_waitcnt lgkmcnt(14)
    v_mfma_f32_32x32x16_bf16 v[32:47], v[136:139], v[164:167], v[32:47]
    ds_read_b64_tr_b16 v[120:121], v234 offset:28672
    ds_read_b64_tr_b16 v[122:123], v234 offset:30720
    s_waitcnt lgkmcnt(14)
    v_mfma_f32_32x32x16_bf16 v[48:63], v[140:143], v[164:167], v[48:63]
    ds_read_b64_tr_b16 v[124:125], v235 offset:28672
    ds_read_b64_tr_b16 v[126:127], v235 offset:30720
    s_waitcnt lgkmcnt(14)
    v_mfma_f32_32x32x16_bf16 v[0:15], v[96:99], v[168:171], v[0:15]
    s_waitcnt lgkmcnt(12)
    v_mfma_f32_32x32x16_bf16 v[16:31], v[100:103], v[168:171], v[16:31]
    s_waitcnt lgkmcnt(10)
    v_mfma_f32_32x32x16_bf16 v[32:47], v[104:107], v[168:171], v[32:47]
    s_waitcnt lgkmcnt(8)
    v_mfma_f32_32x32x16_bf16 v[48:63], v[108:111], v[168:171], v[48:63]
    s_waitcnt lgkmcnt(6)
    v_mfma_f32_32x32x16_bf16 v[0:15], v[112:115], v[172:175], v[0:15]
    s_waitcnt lgkmcnt(4)
    v_mfma_f32_32x32x16_bf16 v[16:31], v[116:119], v[172:175], v[16:31]
    s_waitcnt lgkmcnt(2)
    v_mfma_f32_32x32x16_bf16 v[32:47], v[120:123], v[172:175], v[32:47]
    s_waitcnt lgkmcnt(0)
    v_mfma_f32_32x32x16_bf16 v[48:63], v[124:127], v[172:175], v[48:63]
    s_cmp_eq_u32 s25, s92
    s_cbranch_scc1 L_own_part
    s_lshl_b32 s44, s95, 2
    s_lshl_b32 s47, s93, 4
    s_add_u32 s44, s44, s47
    s_lshl_b32 s44, s44, 14
    s_add_u32 s44, s44, 0x2000000
    s_lshl_b32 s45, s25, 2
    s_add_u32 s45, s45, s92
    s_lshl_b32 s45, s45, 14
    s_add_u32 s44, s44, s45
    v_cvt_pk_bf16_f32 v64, v0, v1
    v_cvt_pk_bf16_f32 v65, v2, v3
    v_cvt_pk_bf16_f32 v66, v4, v5
    v_cvt_pk_bf16_f32 v67, v6, v7
    buffer_store_dwordx4 v[64:67], v228, s[20:23], s44 offen offset:0 sc1
    v_cvt_pk_bf16_f32 v68, v8, v9
    v_cvt_pk_bf16_f32 v69, v10, v11
    v_cvt_pk_bf16_f32 v70, v12, v13
    v_cvt_pk_bf16_f32 v71, v14, v15
    buffer_store_dwordx4 v[68:71], v228, s[20:23], s44 offen offset:1024 sc1
    v_cvt_pk_bf16_f32 v72, v16, v17
    v_cvt_pk_bf16_f32 v73, v18, v19
    v_cvt_pk_bf16_f32 v74, v20, v21
    v_cvt_pk_bf16_f32 v75, v22, v23
    buffer_store_dwordx4 v[72:75], v228, s[20:23], s44 offen offset:2048 sc1
    v_cvt_pk_bf16_f32 v76, v24, v25
    v_cvt_pk_bf16_f32 v77, v26, v27
    v_cvt_pk_bf16_f32 v78, v28, v29
    v_cvt_pk_bf16_f32 v79, v30, v31
    buffer_store_dwordx4 v[76:79], v228, s[20:23], s44 offen offset:3072 sc1
    s_add_u32 s44, s44, 4096
    v_cvt_pk_bf16_f32 v80, v32, v33
    v_cvt_pk_bf16_f32 v81, v34, v35
    v_cvt_pk_bf16_f32 v82, v36, v37
    v_cvt_pk_bf16_f32 v83, v38, v39
    buffer_store_dwordx4 v[80:83], v228, s[20:23], s44 offen offset:0 sc1
    v_cvt_pk_bf16_f32 v84, v40, v41
    v_cvt_pk_bf16_f32 v85, v42, v43
    v_cvt_pk_bf16_f32 v86, v44, v45
    v_cvt_pk_bf16_f32 v87, v46, v47
    buffer_store_dwordx4 v[84:87], v228, s[20:23], s44 offen offset:1024 sc1
    v_cvt_pk_bf16_f32 v88, v48, v49
    v_cvt_pk_bf16_f32 v89, v50, v51
    v_cvt_pk_bf16_f32 v90, v52, v53
    v_cvt_pk_bf16_f32 v91, v54, v55
    buffer_store_dwordx4 v[88:91], v228, s[20:23], s44 offen offset:2048 sc1
    v_cvt_pk_bf16_f32 v92, v56, v57
    v_cvt_pk_bf16_f32 v93, v58, v59
    v_cvt_pk_bf16_f32 v94, v60, v61
    v_cvt_pk_bf16_f32 v95, v62, v63
    buffer_store_dwordx4 v[92:95], v228, s[20:23], s44 offen offset:3072 sc1
    s_barrier
    s_waitcnt vmcnt(0)
    s_branch L_join_part
L_own_part:
    s_barrier
    s_nop 2
    ds_write_b128 v228, v[0:3] offset:0
    ds_write_b128 v228, v[4:7] offset:1024
    ds_write_b128 v228, v[8:11] offset:2048
    ds_write_b128 v228, v[12:15] offset:3072
    ds_write_b128 v228, v[16:19] offset:4096
    ds_write_b128 v228, v[20:23] offset:5120
    ds_write_b128 v228, v[24:27] offset:6144
    ds_write_b128 v228, v[28:31] offset:7168
    ds_write_b128 v228, v[32:35] offset:8192
    ds_write_b128 v228, v[36:39] offset:9216
    ds_write_b128 v228, v[40:43] offset:10240
    ds_write_b128 v228, v[44:47] offset:11264
    ds_write_b128 v228, v[48:51] offset:12288
    ds_write_b128 v228, v[52:55] offset:13312
    ds_write_b128 v228, v[56:59] offset:14336
    ds_write_b128 v228, v[60:63] offset:15360
    s_waitcnt lgkmcnt(0)
L_join_part:
    s_sub_u32 s44, s25, s92
    s_lshl_b32 s44, s44, 10
    s_add_u32 s44, s44, s3
    s_lshl_b32 s45, s92, 2
    s_add_u32 s44, s44, s45
    v_mov_b32 v231, 1
    s_mov_b64 exec, 1
    buffer_store_dword v231, off, s[20:23], s44 offset:128 sc1
    s_mov_b64 exec, -1
    s_barrier
    s_branch L_final
L_y_tail:
    v_mov_b32 v238, v237
    s_nop 1
    v_permlane32_swap_b32 v237, v238
    v_add_f32 v237, v237, v238
    v_rcp_f32 v238, v237
    s_lshl_b32 s44, s28, 13
    s_add_u32 s44, s44, s97
    v_and_b32 v239, 63, v255
    v_lshlrev_b32 v239, 4, v239
    s_lshl_b32 s45, s25, 13
    v_add_u32 v240, s45, v239
    v_pk_mul_f32 v[0:1], v[0:1], v[238:239] op_sel_hi:[1,0]
    v_pk_mul_f32 v[2:3], v[2:3], v[238:239] op_sel_hi:[1,0]
    v_pk_mul_f32 v[4:5], v[4:5], v[238:239] op_sel_hi:[1,0]
    v_pk_mul_f32 v[6:7], v[6:7], v[238:239] op_sel_hi:[1,0]
    v_cvt_pk_bf16_f32 v144, v0, v1
    v_cvt_pk_bf16_f32 v145, v2, v3
    v_cvt_pk_bf16_f32 v146, v4, v5
    v_cvt_pk_bf16_f32 v147, v6, v7
    buffer_store_dwordx4 v[144:147], v239, s[20:23], s44 offen offset:0 sc1
    ds_write_b128 v240, v[144:147] offset:0
    v_pk_mul_f32 v[8:9], v[8:9], v[238:239] op_sel_hi:[1,0]
    v_pk_mul_f32 v[10:11], v[10:11], v[238:239] op_sel_hi:[1,0]
    v_pk_mul_f32 v[12:13], v[12:13], v[238:239] op_sel_hi:[1,0]
    v_pk_mul_f32 v[14:15], v[14:15], v[238:239] op_sel_hi:[1,0]
    v_cvt_pk_bf16_f32 v148, v8, v9
    v_cvt_pk_bf16_f32 v149, v10, v11
    v_cvt_pk_bf16_f32 v150, v12, v13
    v_cvt_pk_bf16_f32 v151, v14, v15
    buffer_store_dwordx4 v[148:151], v239, s[20:23], s44 offen offset:1024 sc1
    ds_write_b128 v240, v[148:151] offset:1024
    v_pk_mul_f32 v[16:17], v[16:17], v[238:239] op_sel_hi:[1,0]
    v_pk_mul_f32 v[18:19], v[18:19], v[238:239] op_sel_hi:[1,0]
    v_pk_mul_f32 v[20:21], v[20:21], v[238:239] op_sel_hi:[1,0]
    v_pk_mul_f32 v[22:23], v[22:23], v[238:239] op_sel_hi:[1,0]
    v_cvt_pk_bf16_f32 v152, v16, v17
    v_cvt_pk_bf16_f32 v153, v18, v19
    v_cvt_pk_bf16_f32 v154, v20, v21
    v_cvt_pk_bf16_f32 v155, v22, v23
    buffer_store_dwordx4 v[152:155], v239, s[20:23], s44 offen offset:2048 sc1
    ds_write_b128 v240, v[152:155] offset:2048
    v_pk_mul_f32 v[24:25], v[24:25], v[238:239] op_sel_hi:[1,0]
    v_pk_mul_f32 v[26:27], v[26:27], v[238:239] op_sel_hi:[1,0]
    v_pk_mul_f32 v[28:29], v[28:29], v[238:239] op_sel_hi:[1,0]
    v_pk_mul_f32 v[30:31], v[30:31], v[238:239] op_sel_hi:[1,0]
    v_cvt_pk_bf16_f32 v156, v24, v25
    v_cvt_pk_bf16_f32 v157, v26, v27
    v_cvt_pk_bf16_f32 v158, v28, v29
    v_cvt_pk_bf16_f32 v159, v30, v31
    buffer_store_dwordx4 v[156:159], v239, s[20:23], s44 offen offset:3072 sc1
    ds_write_b128 v240, v[156:159] offset:3072
    v_pk_mul_f32 v[32:33], v[32:33], v[238:239] op_sel_hi:[1,0]
    v_pk_mul_f32 v[34:35], v[34:35], v[238:239] op_sel_hi:[1,0]
    v_pk_mul_f32 v[36:37], v[36:37], v[238:239] op_sel_hi:[1,0]
    v_pk_mul_f32 v[38:39], v[38:39], v[238:239] op_sel_hi:[1,0]
    v_cvt_pk_bf16_f32 v160, v32, v33
    v_cvt_pk_bf16_f32 v161, v34, v35
    v_cvt_pk_bf16_f32 v162, v36, v37
    v_cvt_pk_bf16_f32 v163, v38, v39
    s_add_u32 s44, s44, 4096
    buffer_store_dwordx4 v[160:163], v239, s[20:23], s44 offen offset:0 sc1
    ds_write_b128 v240, v[160:163] offset:4096
    v_pk_mul_f32 v[40:41], v[40:41], v[238:239] op_sel_hi:[1,0]
    v_pk_mul_f32 v[42:43], v[42:43], v[238:239] op_sel_hi:[1,0]
    v_pk_mul_f32 v[44:45], v[44:45], v[238:239] op_sel_hi:[1,0]
    v_pk_mul_f32 v[46:47], v[46:47], v[238:239] op_sel_hi:[1,0]
    v_cvt_pk_bf16_f32 v164, v40, v41
    v_cvt_pk_bf16_f32 v165, v42, v43
    v_cvt_pk_bf16_f32 v166, v44, v45
    v_cvt_pk_bf16_f32 v167, v46, v47
    buffer_store_dwordx4 v[164:167], v239, s[20:23], s44 offen offset:1024 sc1
    ds_write_b128 v240, v[164:167] offset:5120
    v_pk_mul_f32 v[48:49], v[48:49], v[238:239] op_sel_hi:[1,0]
    v_pk_mul_f32 v[50:51], v[50:51], v[238:239] op_sel_hi:[1,0]
    v_pk_mul_f32 v[52:53], v[52:53], v[238:239] op_sel_hi:[1,0]
    v_pk_mul_f32 v[54:55], v[54:55], v[238:239] op_sel_hi:[1,0]
    v_cvt_pk_bf16_f32 v168, v48, v49
    v_cvt_pk_bf16_f32 v169, v50, v51
    v_cvt_pk_bf16_f32 v170, v52, v53
    v_cvt_pk_bf16_f32 v171, v54, v55
    buffer_store_dwordx4 v[168:171], v239, s[20:23], s44 offen offset:2048 sc1
    ds_write_b128 v240, v[168:171] offset:6144
    v_pk_mul_f32 v[56:57], v[56:57], v[238:239] op_sel_hi:[1,0]
    v_pk_mul_f32 v[58:59], v[58:59], v[238:239] op_sel_hi:[1,0]
    v_pk_mul_f32 v[60:61], v[60:61], v[238:239] op_sel_hi:[1,0]
    v_pk_mul_f32 v[62:63], v[62:63], v[238:239] op_sel_hi:[1,0]
    v_cvt_pk_bf16_f32 v172, v56, v57
    v_cvt_pk_bf16_f32 v173, v58, v59
    v_cvt_pk_bf16_f32 v174, v60, v61
    v_cvt_pk_bf16_f32 v175, v62, v63
    buffer_store_dwordx4 v[172:175], v239, s[20:23], s44 offen offset:3072 sc1
    ds_write_b128 v240, v[172:175] offset:7168
    s_waitcnt lgkmcnt(0)
    s_barrier
    v_and_b32 v230, 63, v255
    v_lshlrev_b32 v230, 8, v230
    s_lshl_b32 s44, s93, 8
    s_sub_u32 s44, s3, s44
    s_lshl_b32 s45, s93, 2
    s_add_u32 s44, s44, s45
    s_lshl_b32 s45, s25, 4
    s_add_u32 s44, s44, s45
    v_mov_b32 v231, 1
    s_waitcnt vmcnt(0)
    s_mov_b64 exec, 15
    buffer_store_dword v231, v230, s[20:23], s44 offen offset:64 sc1
    s_mov_b64 exec, -1
    s_barrier
    s_barrier
L_final:
    s_mov_b32 s96, 400000
L_pl_fin:
    buffer_load_dwordx4 v[208:211], off, s[20:23], s3 offset:128 sc1
    s_waitcnt vmcnt(0)
L_pc_fin:
    v_and_b32 v208, v208, v209
    v_and_b32 v210, v210, v211
    v_and_b32 v208, v208, v210
    s_nop 0
    v_readfirstlane_b32 s44, v208
    s_cmp_eq_u32 s44, 1
    s_cbranch_scc1 L_pd_fin
    s_sub_u32 s96, s96, 1
    s_cbranch_scc0 L_pl_fin
L_pd_fin:
    s_lshl_b32 s44, s95, 2
    s_lshl_b32 s47, s93, 4
    s_add_u32 s44, s44, s47
    s_lshl_b32 s44, s44, 14
    s_add_u32 s44, s44, 0x2000000
    s_lshl_b32 s45, s92, 16
    s_add_u32 s44, s44, s45
    s_lshl_b32 s45, s24, 10
    s_add_u32 s44, s44, s45
    s_lshl_b32 s45, s24, 11
    v_and_b32 v40, 63, v255
    v_lshlrev_b32 v41, 4, v40
    s_add_u32 s46, s92, 1
    s_and_b32 s46, s46, 3
    s_lshl_b32 s46, s46, 14
    s_add_u32 s46, s46, s44
    buffer_load_dwordx4 v[8:11], v41, s[20:23], s46 offen offset:0 sc1
    s_add_u32 s46, s92, 2
    s_and_b32 s46, s46, 3
    s_lshl_b32 s46, s46, 14
    s_add_u32 s46, s46, s44
    buffer_load_dwordx4 v[16:19], v41, s[20:23], s46 offen offset:0 sc1
    s_add_u32 s46, s92, 3
    s_and_b32 s46, s46, 3
    s_lshl_b32 s46, s46, 14
    s_add_u32 s46, s46, s44
    buffer_load_dwordx4 v[24:27], v41, s[20:23], s46 offen offset:0 sc1
    v_add_u32 v42, s45, v41
    ds_read_b128 v[0:3], v42 offset:0
    ds_read_b128 v[4:7], v42 offset:1024
    v_and_b32 v43, 31, v40
    v_lshlrev_b32 v43, 11, v43
    v_lshrrev_b32 v44, 5, v40
    v_lshl_add_u32 v43, v44, 4, v43
    s_lshl_b32 s44, s27, 2
    s_add_u32 s44, s44, s92
    s_lshl_b32 s44, s44, 16
    s_lshl_b32 s45, s29, 10
    s_add_u32 s44, s44, s45
    s_lshl_b32 s45, s49, 8
    s_add_u32 s44, s44, s45
    s_lshl_b32 s45, s24, 5
    s_add_u32 s44, s44, s45
    s_waitcnt lgkmcnt(0)
    s_mov_b32 s46, 0xffff0000
    s_waitcnt vmcnt(2)
    v_lshlrev_b32 v12, 16, v8
    v_and_b32 v8, s46, v8
    v_lshlrev_b32 v13, 16, v9
    v_and_b32 v9, s46, v9
    v_lshlrev_b32 v14, 16, v10
    v_and_b32 v10, s46, v10
    v_lshlrev_b32 v15, 16, v11
    v_and_b32 v11, s46, v11
    v_add_f32 v0, v0, v12
    v_add_f32 v1, v1, v8
    v_add_f32 v2, v2, v13
    v_add_f32 v3, v3, v9
    v_add_f32 v4, v4, v14
    v_add_f32 v5, v5, v10
    v_add_f32 v6, v6, v15
    v_add_f32 v7, v7, v11
    s_waitcnt vmcnt(1)
    v_lshlrev_b32 v20, 16, v16
    v_and_b32 v16, s46, v16
    v_lshlrev_b32 v21, 16, v17
    v_and_b32 v17, s46, v17
    v_lshlrev_b32 v22, 16, v18
    v_and_b32 v18, s46, v18
    v_lshlrev_b32 v23, 16, v19
    v_and_b32 v19, s46, v19
    v_add_f32 v0, v0, v20
    v_add_f32 v1, v1, v16
    v_add_f32 v2, v2, v21
    v_add_f32 v3, v3, v17
    v_add_f32 v4, v4, v22
    v_add_f32 v5, v5, v18
    v_add_f32 v6, v6, v23
    v_add_f32 v7, v7, v19
    s_waitcnt vmcnt(0)
    v_lshlrev_b32 v28, 16, v24
    v_and_b32 v24, s46, v24
    v_lshlrev_b32 v29, 16, v25
    v_and_b32 v25, s46, v25
    v_lshlrev_b32 v30, 16, v26
    v_and_b32 v26, s46, v26
    v_lshlrev_b32 v31, 16, v27
    v_and_b32 v27, s46, v27
    v_add_f32 v0, v0, v28
    v_add_f32 v1, v1, v24
    v_add_f32 v2, v2, v29
    v_add_f32 v3, v3, v25
    v_add_f32 v4, v4, v30
    v_add_f32 v5, v5, v26
    v_add_f32 v6, v6, v31
    v_add_f32 v7, v7, v27
    v_cvt_pk_bf16_f32 v32, v0, v1
    v_cvt_pk_bf16_f32 v33, v2, v3
    v_cvt_pk_bf16_f32 v34, v4, v5
    v_cvt_pk_bf16_f32 v35, v6, v7
    s_nop 0
    v_permlane32_swap_b32 v32, v34
    v_permlane32_swap_b32 v33, v35
    buffer_store_dwordx4 v[32:35], v43, s[88:91], s44 offen
    s_waitcnt vmcnt(0)
    s_waitcnt vmcnt(0)
L_k1_end:
    s_endpgm
L_fb_a:
    s_nop 7
    v_max3_f32 v238, v96, v97, v98
    v_max3_f32 v238, v238, v99, v100
    v_max3_f32 v238, v238, v101, v102
    v_max3_f32 v238, v238, v103, v104
    v_max3_f32 v238, v238, v105, v106
    v_max3_f32 v238, v238, v107, v108
    v_max3_f32 v238, v238, v109, v110
    v_max_f32 v238, v238, v111
    v_mov_b32 v239, v238
    s_nop 1
    v_permlane32_swap_b32 v238, v239
    v_max_f32 v238, v238, v239
    v_max_f32 v238, s41, v238
    v_sub_f32 v240, 0, v238
    v_exp_f32 v240, v240
    v_sub_f32 v96, v96, v238
    v_sub_f32 v97, v97, v238
    v_sub_f32 v98, v98, v238
    v_sub_f32 v99, v99, v238
    v_sub_f32 v100, v100, v238
    v_sub_f32 v101, v101, v238
    v_sub_f32 v102, v102, v238
    v_sub_f32 v103, v103, v238
    v_sub_f32 v104, v104, v238
    v_sub_f32 v105, v105, v238
    v_sub_f32 v106, v106, v238
    v_sub_f32 v107, v107, v238
    v_sub_f32 v108, v108, v238
    v_sub_f32 v109, v109, v238
    v_sub_f32 v110, v110, v238
    v_sub_f32 v111, v111, v238
    v_min_f32 v240, s42, v240
    v_sub_f32 v112, v112, v238
    v_sub_f32 v113, v113, v238
    v_sub_f32 v114, v114, v238
    v_sub_f32 v115, v115, v238
    v_sub_f32 v116, v116, v238
    v_sub_f32 v117, v117, v238
    v_sub_f32 v118, v118, v238
    v_sub_f32 v119, v119, v238
    v_sub_f32 v120, v120, v238
    v_sub_f32 v121, v121, v238
    v_sub_f32 v122, v122, v238
    v_sub_f32 v123, v123, v238
    v_sub_f32 v124, v124, v238
    v_sub_f32 v125, v125, v238
    v_sub_f32 v126, v126, v238
    v_sub_f32 v127, v127, v238
    v_sub_f32 v128, v128, v238
    v_sub_f32 v129, v129, v238
    v_sub_f32 v130, v130, v238
    v_sub_f32 v131, v131, v238
    v_sub_f32 v132, v132, v238
    v_sub_f32 v133, v133, v238
    v_sub_f32 v134, v134, v238
    v_sub_f32 v135, v135, v238
    v_sub_f32 v136, v136, v238
    v_sub_f32 v137, v137, v238
    v_sub_f32 v138, v138, v238
    v_sub_f32 v139, v139, v238
    v_sub_f32 v140, v140, v238
    v_sub_f32 v141, v141, v238
    v_sub_f32 v142, v142, v238
    v_sub_f32 v143, v143, v238
    s_cmp_eq_u32 s42, 0
    s_cbranch_scc1 L_fbs_a
    v_pk_mul_f32 v[0:1], v[0:1], v[240:241] op_sel_hi:[1,0]
    v_pk_mul_f32 v[2:3], v[2:3], v[240:241] op_sel_hi:[1,0]
    v_pk_mul_f32 v[4:5], v[4:5], v[240:241] op_sel_hi:[1,0]
    v_pk_mul_f32 v[6:7], v[6:7], v[240:241] op_sel_hi:[1,0]
    v_pk_mul_f32 v[8:9], v[8:9], v[240:241] op_sel_hi:[1,0]
    v_pk_mul_f32 v[10:11], v[10:11], v[240:241] op_sel_hi:[1,0]
    v_pk_mul_f32 v[12:13], v[12:13], v[240:241] op_sel_hi:[1,0]
    v_pk_mul_f32 v[14:15], v[14:15], v[240:241] op_sel_hi:[1,0]
    v_pk_mul_f32 v[16:17], v[16:17], v[240:241] op_sel_hi:[1,0]
    v_pk_mul_f32 v[18:19], v[18:19], v[240:241] op_sel_hi:[1,0]
    v_pk_mul_f32 v[20:21], v[20:21], v[240:241] op_sel_hi:[1,0]
    v_pk_mul_f32 v[22:23], v[22:23], v[240:241] op_sel_hi:[1,0]
    v_pk_mul_f32 v[24:25], v[24:25], v[240:241] op_sel_hi:[1,0]
    v_pk_mul_f32 v[26:27], v[26:27], v[240:241] op_sel_hi:[1,0]
    v_pk_mul_f32 v[28:29], v[28:29], v[240:241] op_sel_hi:[1,0]
    v_pk_mul_f32 v[30:31], v[30:31], v[240:241] op_sel_hi:[1,0]
    v_pk_mul_f32 v[32:33], v[32:33], v[240:241] op_sel_hi:[1,0]
    v_pk_mul_f32 v[34:35], v[34:35], v[240:241] op_sel_hi:[1,0]
    v_pk_mul_f32 v[36:37], v[36:37], v[240:241] op_sel_hi:[1,0]
    v_pk_mul_f32 v[38:39], v[38:39], v[240:241] op_sel_hi:[1,0]
    v_pk_mul_f32 v[40:41], v[40:41], v[240:241] op_sel_hi:[1,0]
    v_pk_mul_f32 v[42:43], v[42:43], v[240:241] op_sel_hi:[1,0]
    v_pk_mul_f32 v[44:45], v[44:45], v[240:241] op_sel_hi:[1,0]
    v_pk_mul_f32 v[46:47], v[46:47], v[240:241] op_sel_hi:[1,0]
    v_pk_mul_f32 v[48:49], v[48:49], v[240:241] op_sel_hi:[1,0]
    v_pk_mul_f32 v[50:51], v[50:51], v[240:241] op_sel_hi:[1,0]
    v_pk_mul_f32 v[52:53], v[52:53], v[240:241] op_sel_hi:[1,0]
    v_pk_mul_f32 v[54:55], v[54:55], v[240:241] op_sel_hi:[1,0]
    v_pk_mul_f32 v[56:57], v[56:57], v[240:241] op_sel_hi:[1,0]
    v_pk_mul_f32 v[58:59], v[58:59], v[240:241] op_sel_hi:[1,0]
    v_pk_mul_f32 v[60:61], v[60:61], v[240:241] op_sel_hi:[1,0]
    v_pk_mul_f32 v[62:63], v[62:63], v[240:241] op_sel_hi:[1,0]
L_fbs_a:
    v_mul_f32 v236, v240, v237
    v_exp_f32 v238, v96
    v_exp_f32 v239, v97
    v_add_f32 v236, v236, v238
    v_add_f32 v236, v236, v239
    v_cvt_pk_bf16_f32 v208, v238, v239
    v_exp_f32 v240, v98
    v_exp_f32 v241, v99
    v_add_f32 v236, v236, v240
    v_add_f32 v236, v236, v241
    v_cvt_pk_bf16_f32 v209, v240, v241
    v_exp_f32 v238, v100
    v_exp_f32 v239, v101
    v_add_f32 v236, v236, v238
    v_add_f32 v236, v236, v239
    v_cvt_pk_bf16_f32 v210, v238, v239
    v_exp_f32 v240, v102
    v_exp_f32 v241, v103
    v_add_f32 v236, v236, v240
    v_add_f32 v236, v236, v241
    v_cvt_pk_bf16_f32 v211, v240, v241
    v_exp_f32 v238, v104
    v_exp_f32 v239, v105
    v_add_f32 v236, v236, v238
    v_add_f32 v236, v236, v239
    v_cvt_pk_bf16_f32 v212, v238, v239
    v_exp_f32 v240, v106
    v_exp_f32 v241, v107
    v_add_f32 v236, v236, v240
    v_add_f32 v236, v236, v241
    v_cvt_pk_bf16_f32 v213, v240, v241
    v_exp_f32 v238, v108
    v_exp_f32 v239, v109
    v_add_f32 v236, v236, v238
    v_add_f32 v236, v236, v239
    v_cvt_pk_bf16_f32 v214, v238, v239
    v_exp_f32 v240, v110
    v_exp_f32 v241, v111
    v_add_f32 v236, v236, v240
    v_add_f32 v236, v236, v241
    v_cvt_pk_bf16_f32 v215, v240, v241
    s_mov_b32 s40, 0x46800000
    s_mov_b32 s41, 0
    s_mov_b32 s42, 1.0
    s_branch L_fbret_a
L_fb_b:
    s_nop 7
    v_max3_f32 v238, v112, v113, v114
    v_max3_f32 v238, v238, v115, v116
    v_max3_f32 v238, v238, v117, v118
    v_max3_f32 v238, v238, v119, v120
    v_max3_f32 v238, v238, v121, v122
    v_max3_f32 v238, v238, v123, v124
    v_max3_f32 v238, v238, v125, v126
    v_max_f32 v238, v238, v127
    v_mov_b32 v239, v238
    s_nop 1
    v_permlane32_swap_b32 v238, v239
    v_max_f32 v238, v238, v239
    v_max_f32 v238, s41, v238
    v_sub_f32 v240, 0, v238
    v_exp_f32 v240, v240
    v_sub_f32 v112, v112, v238
    v_sub_f32 v113, v113, v238
    v_sub_f32 v114, v114, v238
    v_sub_f32 v115, v115, v238
    v_sub_f32 v116, v116, v238
    v_sub_f32 v117, v117, v238
    v_sub_f32 v118, v118, v238
    v_sub_f32 v119, v119, v238
    v_sub_f32 v120, v120, v238
    v_sub_f32 v121, v121, v238
    v_sub_f32 v122, v122, v238
    v_sub_f32 v123, v123, v238
    v_sub_f32 v124, v124, v238
    v_sub_f32 v125, v125, v238
    v_sub_f32 v126, v126, v238
    v_sub_f32 v127, v127, v238
    v_min_f32 v240, s42, v240
    v_sub_f32 v128, v128, v238
    v_sub_f32 v129, v129, v238
    v_sub_f32 v130, v130, v238
    v_sub_f32 v131, v131, v238
    v_sub_f32 v132, v132, v238
    v_sub_f32 v133, v133, v238
    v_sub_f32 v134, v134, v238
    v_sub_f32 v135, v135, v238
    v_sub_f32 v136, v136, v238
    v_sub_f32 v137, v137, v238
    v_sub_f32 v138, v138, v238
    v_sub_f32 v139, v139, v238
    v_sub_f32 v140, v140, v238
    v_sub_f32 v141, v141, v238
    v_sub_f32 v142, v142, v238
    v_sub_f32 v143, v143, v238
    s_cmp_eq_u32 s42, 0
    s_cbranch_scc1 L_fbs_b
    v_pk_mul_f32 v[0:1], v[0:1], v[240:241] op_sel_hi:[1,0]
    v_pk_mul_f32 v[2:3], v[2:3], v[240:241] op_sel_hi:[1,0]
    v_pk_mul_f32 v[4:5], v[4:5], v[240:241] op_sel_hi:[1,0]
    v_pk_mul_f32 v[6:7], v[6:7], v[240:241] op_sel_hi:[1,0]
    v_pk_mul_f32 v[8:9], v[8:9], v[240:241] op_sel_hi:[1,0]
    v_pk_mul_f32 v[10:11], v[10:11], v[240:241] op_sel_hi:[1,0]
    v_pk_mul_f32 v[12:13], v[12:13], v[240:241] op_sel_hi:[1,0]
    v_pk_mul_f32 v[14:15], v[14:15], v[240:241] op_sel_hi:[1,0]
    v_pk_mul_f32 v[16:17], v[16:17], v[240:241] op_sel_hi:[1,0]
    v_pk_mul_f32 v[18:19], v[18:19], v[240:241] op_sel_hi:[1,0]
    v_pk_mul_f32 v[20:21], v[20:21], v[240:241] op_sel_hi:[1,0]
    v_pk_mul_f32 v[22:23], v[22:23], v[240:241] op_sel_hi:[1,0]
    v_pk_mul_f32 v[24:25], v[24:25], v[240:241] op_sel_hi:[1,0]
    v_pk_mul_f32 v[26:27], v[26:27], v[240:241] op_sel_hi:[1,0]
    v_pk_mul_f32 v[28:29], v[28:29], v[240:241] op_sel_hi:[1,0]
    v_pk_mul_f32 v[30:31], v[30:31], v[240:241] op_sel_hi:[1,0]
    v_pk_mul_f32 v[32:33], v[32:33], v[240:241] op_sel_hi:[1,0]
    v_pk_mul_f32 v[34:35], v[34:35], v[240:241] op_sel_hi:[1,0]
    v_pk_mul_f32 v[36:37], v[36:37], v[240:241] op_sel_hi:[1,0]
    v_pk_mul_f32 v[38:39], v[38:39], v[240:241] op_sel_hi:[1,0]
    v_pk_mul_f32 v[40:41], v[40:41], v[240:241] op_sel_hi:[1,0]
    v_pk_mul_f32 v[42:43], v[42:43], v[240:241] op_sel_hi:[1,0]
    v_pk_mul_f32 v[44:45], v[44:45], v[240:241] op_sel_hi:[1,0]
    v_pk_mul_f32 v[46:47], v[46:47], v[240:241] op_sel_hi:[1,0]
    v_pk_mul_f32 v[48:49], v[48:49], v[240:241] op_sel_hi:[1,0]
    v_pk_mul_f32 v[50:51], v[50:51], v[240:241] op_sel_hi:[1,0]
    v_pk_mul_f32 v[52:53], v[52:53], v[240:241] op_sel_hi:[1,0]
    v_pk_mul_f32 v[54:55], v[54:55], v[240:241] op_sel_hi:[1,0]
    v_pk_mul_f32 v[56:57], v[56:57], v[240:241] op_sel_hi:[1,0]
    v_pk_mul_f32 v[58:59], v[58:59], v[240:241] op_sel_hi:[1,0]
    v_pk_mul_f32 v[60:61], v[60:61], v[240:241] op_sel_hi:[1,0]
    v_pk_mul_f32 v[62:63], v[62:63], v[240:241] op_sel_hi:[1,0]
L_fbs_b:
    v_mul_f32 v237, v240, v236
    v_exp_f32 v238, v112
    v_exp_f32 v239, v113
    v_add_f32 v237, v237, v238
    v_add_f32 v237, v237, v239
    v_cvt_pk_bf16_f32 v216, v238, v239
    v_exp_f32 v240, v114
    v_exp_f32 v241, v115
    v_add_f32 v237, v237, v240
    v_add_f32 v237, v237, v241
    v_cvt_pk_bf16_f32 v217, v240, v241
    v_exp_f32 v238, v116
    v_exp_f32 v239, v117
    v_add_f32 v237, v237, v238
    v_add_f32 v237, v237, v239
    v_cvt_pk_bf16_f32 v218, v238, v239
    v_exp_f32 v240, v118
    v_exp_f32 v241, v119
    v_add_f32 v237, v237, v240
    v_add_f32 v237, v237, v241
    v_cvt_pk_bf16_f32 v219, v240, v241
    v_exp_f32 v238, v120
    v_exp_f32 v239, v121
    v_add_f32 v237, v237, v238
    v_add_f32 v237, v237, v239
    v_cvt_pk_bf16_f32 v220, v238, v239
    v_exp_f32 v240, v122
    v_exp_f32 v241, v123
    v_add_f32 v237, v237, v240
    v_add_f32 v237, v237, v241
    v_cvt_pk_bf16_f32 v221, v240, v241
    v_exp_f32 v238, v124
    v_exp_f32 v239, v125
    v_add_f32 v237, v237, v238
    v_add_f32 v237, v237, v239
    v_cvt_pk_bf16_f32 v222, v238, v239
    v_exp_f32 v240, v126
    v_exp_f32 v241, v127
    v_add_f32 v237, v237, v240
    v_add_f32 v237, v237, v241
    v_cvt_pk_bf16_f32 v223, v240, v241
    s_mov_b32 s40, 0x46800000
    s_mov_b32 s41, 0
    s_mov_b32 s42, 1.0
    s_branch L_fbret_b
.section .rodata,"a"
.p2align 6
.amdhsa_kernel concat_heads__mha_block_cached__mha_block_cached__near_ridge_kernel
  .amdhsa_next_free_vgpr 256
  .amdhsa_next_free_sgpr 102
  .amdhsa_accum_offset 256
  .amdhsa_group_segment_fixed_size 0
  .amdhsa_kernarg_size 104
  .amdhsa_user_sgpr_count 2
  .amdhsa_user_sgpr_kernarg_segment_ptr 1
  .amdhsa_system_sgpr_workgroup_id_x 1
.end_amdhsa_kernel
```
